```python
import torch

def _softmax(x, axis=-1):
    return torch.softmax(x, dim=axis)
def _gelu(x):
    return torch.nn.functional.gelu(x, approximate="tanh")
def _silu(x):
    return torch.nn.functional.silu(x)
def _sigmoid(x):
    return torch.sigmoid(x)
def _layernorm(x, axis=-1, eps=1e-5):
    m = x.mean(dim=axis, keepdim=True)
    v = x.var(dim=axis, keepdim=True, unbiased=False)
    return (x - m) / torch.sqrt(v + eps)
def _scatter_add(tgt, idx, src, axis=0):
    return tgt.clone().index_add_(axis, idx, src)
def _segment_sum(src, seg, n):
    out = torch.zeros((n,) + src.shape[1:], dtype=src.dtype)
    return out.index_add_(0, seg, src)
def _pad(x, pw):
    flat = tuple(v for pair in reversed(pw) for v in pair)
    return torch.nn.functional.pad(x, flat)

kernel_name = 'sequential_preLN__mha_block__dense_activation_squared_relu__prompt'

def setup_inputs():

    _w = (lambda a: (lambda t: t.to(torch.bfloat16) if t.is_floating_point() else t)(torch.as_tensor(a)))
    def _A_setup():
        B, S, D, H = 1, 2048, 640, 32
        return {
            "x": _w((lambda *s: torch.randn(*s, dtype=torch.bfloat16) * 0.05)(B, S, D)),
            "wqkv": _w((lambda *s: torch.randn(*s, dtype=torch.bfloat16) * 0.05)(D, 3 * D)),
            "wo": _w((lambda *s: torch.randn(*s, dtype=torch.bfloat16) * 0.05)(D, D)),
        }
    _A_in = _A_setup()

    def _B_setup():
        B, S, D, F = 1, 2048, 640, 1536
        return {
            "x": _w((lambda *s: torch.randn(*s, dtype=torch.bfloat16) * 0.05)(B, S, D)),
            "w1": _w((lambda *s: torch.randn(*s, dtype=torch.bfloat16) * 0.05)(D, F)),
            "b1": _w((lambda *s: torch.randn(*s, dtype=torch.bfloat16) * 0.8)(F)),
            "w2": _w((lambda *s: torch.randn(*s, dtype=torch.bfloat16) * 0.05)(F, D)),
            "b2": _w((lambda *s: torch.randn(*s, dtype=torch.bfloat16) * 3.2)(D)),
        }
    _B_in = _B_setup()

    return {
        "A_x": _A_in["x"],
        "A_wqkv": _A_in["wqkv"],
        "A_wo": _A_in["wo"],
        "B_x": _B_in["x"],
        "B_w1": _B_in["w1"],
        "B_b1": _B_in["b1"],
        "B_w2": _B_in["w2"],
        "B_b2": _B_in["b2"],
    }

def reference(A_x, A_wqkv, A_wo, B_x, B_w1, B_b1, B_w2, B_b2):
    def _A_ref(x, wqkv, wo):
        B, S, D = x.shape
        H = 32
        Dh = D // H
        qkv = (lambda x, *d: x.permute(*d))((x @ wqkv).reshape(B, S, 3, H, Dh), 2, 0, 3, 1, 4)
        q, k, v = qkv[0], qkv[1], qkv[2]
        scores = torch.einsum("bhqd,bhkd->bhqk", q, k) * (Dh ** -0.5)
        p = _softmax(scores, axis=-1)
        o = torch.einsum("bhqk,bhkd->bhqd", p, v)
        return (lambda x, *d: x.permute(*d))(o, 0, 2, 1, 3).reshape(B, S, D) @ wo

    def _B_ref(x, w1, b1, w2, b2):
        h = torch.einsum("bsd,df->bsf", x, w1) + b1
        zero = torch.zeros_like(h)
        r = torch.where(h > zero, h, zero)
        h = r * r
        out = torch.einsum("bsf,fd->bsd", h, w2) + b2
        return out

    x = A_x
    h = x + _A_ref(_layernorm(x, axis=-1), A_wqkv, A_wo)
    h2 = h + _B_ref(_layernorm(h, axis=-1), B_w1, B_b1, B_w2, B_b2)
    return h2
```

```asm
; @launch kernel=sequential_preLN__mha_block__dense_activation_squared_relu__prompt_kernel grid=(256,1,1) block=(512,1,1) lds=163840
.amdgcn_target "amdgcn-amd-amdhsa--gfx950"
.text
.globl sequential_preLN__mha_block__dense_activation_squared_relu__prompt_kernel
.p2align 8
.type sequential_preLN__mha_block__dense_activation_squared_relu__prompt_kernel,@function
sequential_preLN__mha_block__dense_activation_squared_relu__prompt_kernel:
    s_cmp_ge_u32 s2, 256
    s_cbranch_scc1 F_end
    s_load_dwordx4 s[8:11], s[0:1], 0
    s_load_dwordx2 s[16:17], s[0:1], 80
    s_load_dwordx2 s[44:45], s[0:1], 32
    s_load_dwordx2 s[52:53], s[0:1], 48
    s_load_dwordx2 s[48:49], s[0:1], 16
    s_load_dwordx2 s[56:57], s[0:1], 40
    s_load_dwordx2 s[64:65], s[0:1], 72
    v_lshrrev_b32 v2, 6, v0
    v_and_b32 v1, 63, v0
    v_readfirstlane_b32 s20, v2
    s_bfe_u32 s32, s2, 0x20001
    s_bfe_u32 s34, s2, 0x20003
    s_lshl2_add_u32 s23, s32, s34
    s_and_b32 s32, s2, 1
    s_lshr_b32 s33, s2, 5
    s_lshl3_add_u32 s24, s32, s33
    s_and_b32 s42, s20, 3
    s_cmp_eq_u32 s24, 15
    s_cbranch_scc1 A_aux
    s_cmp_lt_u32 s20, 4
    s_cbranch_scc1 A_comp
    s_mul_i32 s34, s34, 3
    s_add_u32 s34, s34, s33
    s_cmp_ge_u32 s34, 10
    s_cselect_b32 s32, 10, 0
    s_sub_u32 s34, s34, s32
    v_lshrrev_b32 v2, 3, v1
    v_mul_u32_u24 v2, 1280, v2
    v_and_b32 v3, 7, v1
    v_lshrrev_b32 v4, 4, v1
    v_xor_b32 v3, v3, v4
    v_lshl_add_u32 v7, v3, 4, v2
    v_xor_b32 v8, 64, v7
    v_bfe_u32 v2, v1, 2, 2
    v_mul_u32_u24 v2, 3840, v2
    v_lshl_add_u32 v2, v4, 6, v2
    v_and_b32 v3, 3, v1
    v_lshl_add_u32 v9, v3, 4, v2
    s_lshl2_add_u32 s27, s23, s42
    s_mul_i32 s27, s27, 40960
    s_mul_i32 s28, s42, 61440
    s_lshl_b32 s32, s24, 8
    s_add_u32 s28, s28, s32
    s_lshl_b32 s31, s42, 12
    s_mov_b32 s26, 0xfffffffd
    s_waitcnt lgkmcnt(0)
    s_mov_b64 s[12:13], s[10:11]
    s_mov_b32 s10, 0x280000
    s_mov_b32 s11, 0x20000
    s_mov_b32 s14, 0x258000
    s_mov_b32 s15, 0x20000
    s_mov_b32 s66, 0x100
    s_mov_b32 s67, 0x20000
    v_and_b32 v45, 15, v1
    v_lshlrev_b32 v45, 2, v45
    v_mov_b32 v46, 0
A_hpro:
    s_lshl_b32 s29, s34, 7
    s_add_u32 s29, s29, s27
    s_mul_i32 s30, s34, 245760
    s_add_u32 s30, s30, s28
    s_add_u32 m0, s31, 0
    s_nop 0
    buffer_load_dwordx4 v7, s[8:11], s29 offen lds
    s_add_u32 m0, s31, 16384
    s_nop 0
    buffer_load_dwordx4 v9, s[12:15], s30 offen lds
    s_add_u32 m0, s31, 1024
    s_add_u32 s29, s29, 10240
    buffer_load_dwordx4 v8, s[8:11], s29 offen lds
    s_add_u32 m0, s31, 17408
    s_add_u32 s30, s30, 15360
    buffer_load_dwordx4 v9, s[12:15], s30 offen lds
    s_add_u32 m0, s31, 2048
    s_add_u32 s29, s29, 10240
    buffer_load_dwordx4 v7, s[8:11], s29 offen lds
    s_add_u32 m0, s31, 18432
    s_add_u32 s30, s30, 15360
    buffer_load_dwordx4 v9, s[12:15], s30 offen lds
    s_add_u32 m0, s31, 3072
    s_add_u32 s29, s29, 10240
    buffer_load_dwordx4 v8, s[8:11], s29 offen lds
    s_add_u32 m0, s31, 19456
    s_add_u32 s30, s30, 15360
    buffer_load_dwordx4 v9, s[12:15], s30 offen lds
    s_add_u32 s34, s34, 1
    s_cmp_eq_u32 s34, 10
    s_cselect_b32 s34, 0, s34
    s_add_u32 s31, s31, 32768
    s_cmp_ge_u32 s31, 163840
    s_cselect_b32 s32, 163840, 0
    s_sub_u32 s31, s31, s32
    s_add_u32 s26, s26, 1
    s_cmp_lg_u32 s26, 0xffffffff
    s_cbranch_scc1 A_hpro
    s_waitcnt vmcnt(8)
    s_barrier
    s_mov_b32 s26, -1
    s_branch A_hin
A_hloop:
    s_waitcnt vmcnt(16)
    s_barrier
    s_cmp_lg_u32 s26, 4
    s_cbranch_scc1 A_hin
    buffer_load_dword v46, v45, s[64:67], 0 offen sc1
A_hin:
    s_lshl_b32 s29, s34, 7
    s_add_u32 s29, s29, s27
    s_mul_i32 s30, s34, 245760
    s_add_u32 s30, s30, s28
    s_add_u32 m0, s31, 0
    s_nop 0
    buffer_load_dwordx4 v7, s[8:11], s29 offen lds
    s_add_u32 m0, s31, 16384
    s_nop 0
    buffer_load_dwordx4 v9, s[12:15], s30 offen lds
    s_add_u32 m0, s31, 1024
    s_add_u32 s29, s29, 10240
    buffer_load_dwordx4 v8, s[8:11], s29 offen lds
    s_add_u32 m0, s31, 17408
    s_add_u32 s30, s30, 15360
    buffer_load_dwordx4 v9, s[12:15], s30 offen lds
    s_add_u32 m0, s31, 2048
    s_add_u32 s29, s29, 10240
    buffer_load_dwordx4 v7, s[8:11], s29 offen lds
    s_add_u32 m0, s31, 18432
    s_add_u32 s30, s30, 15360
    buffer_load_dwordx4 v9, s[12:15], s30 offen lds
    s_add_u32 m0, s31, 3072
    s_add_u32 s29, s29, 10240
    buffer_load_dwordx4 v8, s[8:11], s29 offen lds
    s_add_u32 m0, s31, 19456
    s_add_u32 s30, s30, 15360
    buffer_load_dwordx4 v9, s[12:15], s30 offen lds
    s_add_u32 s34, s34, 1
    s_cmp_eq_u32 s34, 10
    s_cselect_b32 s34, 0, s34
    s_add_u32 s31, s31, 32768
    s_cmp_ge_u32 s31, 163840
    s_cselect_b32 s32, 163840, 0
    s_sub_u32 s31, s31, s32
    s_add_u32 s26, s26, 1
    s_cmp_eq_u32 s26, 0
    s_cbranch_scc1 A_hin
    s_cmp_lt_u32 s26, 7
    s_cbranch_scc1 A_hloop
    s_mov_b32 s18, 0x2000000
    s_mov_b32 s19, 0x20000
    s_mul_i32 s27, s23, 15
    s_add_u32 s27, s27, s24
    s_cmp_ge_u32 s27, 136
    s_cbranch_scc1 A_t1
    s_mov_b32 s29, 0x28
    s_mov_b32 s31, 0x6666667
    s_mov_b32 s34, 0x500
    s_mov_b32 s36, 0x0
    s_and_b32 s30, s27, 1
    s_lshl2_add_u32 s28, s30, s42
    s_mul_i32 s30, s30, 640
    s_cmp_ge_u32 s27, 96
    s_cbranch_scc1 A_to
    s_mov_b64 s[4:5], s[52:53]
    s_mov_b32 s6, 1966080
    s_lshr_b32 s37, s27, 1
    s_lshl2_add_u32 s43, s37, s42
    s_mul_i32 s43, s43, 10240
    s_cmp_ge_u32 s37, 24
    s_cselect_b32 s32, 24, 0
    s_sub_u32 s37, s37, s32
    s_sub_u32 s33, s28, 6
    s_min_u32 s33, s33, s28
    s_mul_i32 s33, s33, 4
    s_sub_u32 s37, s37, s33
    s_add_u32 s33, s37, 24
    s_min_u32 s37, s37, s33
    s_add_u32 s37, s37, s32
    s_mul_i32 s37, s37, 5120
    s_mul_i32 s3, s28, 245760
    s_add_u32 s3, s3, s37
    s_add_u32 s3, s3, 0x1600000
    s_branch A_tc
A_to:
    s_mov_b64 s[4:5], s[48:49]
    s_mov_b32 s6, 819200
    s_sub_u32 s37, s27, 96
    s_lshr_b32 s37, s37, 1
    s_mul_i32 s32, s37, 52
    s_lshr_b32 s32, s32, 8
    s_mul_i32 s33, s32, 5
    s_sub_u32 s33, s37, s33
    s_mul_i32 s43, s32, 160
    s_lshr_b32 s32, s42, 1
    s_mul_i32 s32, s32, 4
    s_lshl3_add_u32 s32, s42, s32
    s_mul_i32 s35, s33, 40
    s_add_u32 s32, s32, s35
    s_mul_i32 s35, s42, 40
    s_add_u32 s35, s35, 16
    s_cmp_eq_u32 s33, 4
    s_cselect_b32 s32, s35, s32
    s_cselect_b32 s36, 20480, 0
    s_add_u32 s43, s43, s32
    s_mul_i32 s43, s43, 1280
    s_cmp_ge_u32 s37, 10
    s_cselect_b32 s32, 10, 0
    s_sub_u32 s37, s37, s32
    s_sub_u32 s33, s28, 5
    s_min_u32 s33, s33, s28
    s_mul_i32 s33, s33, 2
    s_sub_u32 s37, s37, s33
    s_add_u32 s33, s37, 10
    s_min_u32 s37, s37, s33
    s_add_u32 s37, s37, s32
    s_mul_i32 s37, s37, 5120
    s_mul_i32 s3, s28, 102400
    s_add_u32 s3, s3, s37
    s_add_u32 s3, s3, 0x1300000
    s_branch A_tc
A_t1:
    s_mov_b32 s29, 0x30
    s_mov_b32 s31, 0x5555556
    s_mov_b32 s34, 0xc00
    s_mov_b32 s36, 0x0
    s_mov_b64 s[4:5], s[44:45]
    s_mov_b32 s6, 1966080
    s_sub_u32 s27, s27, 136
    s_and_b32 s30, s27, 3
    s_lshl2_add_u32 s28, s30, s42
    s_mul_i32 s30, s30, 768
    s_lshr_b32 s37, s27, 2
    s_lshl2_add_u32 s43, s37, s42
    s_mul_i32 s43, s43, 24576
    s_cmp_ge_u32 s37, 20
    s_cselect_b32 s32, 20, 0
    s_sub_u32 s37, s37, s32
    s_sub_u32 s33, s28, 10
    s_min_u32 s33, s33, s28
    s_mul_i32 s33, s33, 2
    s_sub_u32 s37, s37, s33
    s_add_u32 s33, s37, 20
    s_min_u32 s37, s37, s33
    s_add_u32 s37, s37, s32
    s_mul_i32 s37, s37, 6144
    s_mul_i32 s3, s28, 122880
    s_add_u32 s3, s3, s37
    s_add_u32 s3, s3, 0x1400000
    s_cmp_lt_u32 s27, 80
    s_cselect_b32 s3, s3, 0x40000000
A_tc:
    s_mov_b32 s7, 0x20000
    s_add_u32 s43, s43, s30
    s_lshl_b32 s33, s29, 4
    s_sub_u32 s34, s34, s33
    v_add_u32 v2, 0, v1
    v_mul_hi_u32 v3, s31, v2
    v_mul_u32_u24 v4, s34, v3
    v_lshl_add_u32 v4, v2, 4, v4
    v_lshrrev_b32 v3, 2, v3
    v_mul_u32_u24 v3, s36, v3
    v_add_u32 v20, v4, v3
    v_add_u32 v2, 64, v1
    v_mul_hi_u32 v3, s31, v2
    v_mul_u32_u24 v4, s34, v3
    v_lshl_add_u32 v4, v2, 4, v4
    v_lshrrev_b32 v3, 2, v3
    v_mul_u32_u24 v3, s36, v3
    v_add_u32 v21, v4, v3
    v_add_u32 v2, 128, v1
    v_mul_hi_u32 v3, s31, v2
    v_mul_u32_u24 v4, s34, v3
    v_lshl_add_u32 v4, v2, 4, v4
    v_lshrrev_b32 v3, 2, v3
    v_mul_u32_u24 v3, s36, v3
    v_add_u32 v22, v4, v3
    v_add_u32 v2, 192, v1
    v_mul_hi_u32 v3, s31, v2
    v_mul_u32_u24 v4, s34, v3
    v_lshl_add_u32 v4, v2, 4, v4
    v_lshrrev_b32 v3, 2, v3
    v_mul_u32_u24 v3, s36, v3
    v_add_u32 v23, v4, v3
    v_add_u32 v2, 256, v1
    v_mul_hi_u32 v3, s31, v2
    v_mul_u32_u24 v4, s34, v3
    v_lshl_add_u32 v4, v2, 4, v4
    v_lshrrev_b32 v3, 2, v3
    v_mul_u32_u24 v3, s36, v3
    v_add_u32 v24, v4, v3
    v_add_u32 v2, 320, v1
    v_mul_hi_u32 v3, s31, v2
    v_mul_u32_u24 v4, s34, v3
    v_lshl_add_u32 v4, v2, 4, v4
    v_lshrrev_b32 v3, 2, v3
    v_mul_u32_u24 v3, s36, v3
    v_add_u32 v25, v4, v3
    s_mul_i32 s30, s33, 8
    s_mul_i32 s30, s30, s42
    s_add_u32 s30, s30, 4096
    s_mov_b32 s71, s29
    s_waitcnt vmcnt(16)
    s_barrier
    v_mov_b32 v2, v45
    v_mov_b32 v3, v46
    s_mov_b32 s35, 0x10000
    s_nop 0
A_pollh:
    v_cmp_eq_u32 vcc, 0, v3
    s_cbranch_vccz A_pollxh
    buffer_load_dword v3, v2, s[64:67], 0 offen sc1
    s_waitcnt vmcnt(0)
    s_sub_u32 s35, s35, 1
    s_cbranch_scc0 A_pollh
A_pollxh:
    s_lshl_b32 s33, s23, 10
    s_add_u32 s33, s33, 19791872
    v_and_b32 v2, 127, v0
    v_lshlrev_b32 v4, 3, v2
    buffer_load_dwordx2 v[36:37], v4, s[16:19], s33 offen sc1
    s_add_u32 m0, s30, 0
    s_nop 0
    buffer_load_dwordx4 v20, s[4:7], s43 offen lds
    s_add_u32 m0, s30, 1024
    s_nop 0
    buffer_load_dwordx4 v21, s[4:7], s43 offen lds
    s_add_u32 m0, s30, 2048
    s_nop 0
    buffer_load_dwordx4 v22, s[4:7], s43 offen lds
    s_add_u32 m0, s30, 3072
    s_nop 0
    buffer_load_dwordx4 v23, s[4:7], s43 offen lds
    s_add_u32 m0, s30, 4096
    s_nop 0
    buffer_load_dwordx4 v24, s[4:7], s43 offen lds
    s_cmp_eq_u32 s29, 40
    s_cselect_b32 s30, 23552, s30
    s_add_u32 m0, s30, 5120
    s_nop 0
    buffer_load_dwordx4 v25, s[4:7], s43 offen lds
    v_lshlrev_b32 v2, 2, v2
    s_waitcnt vmcnt(15)
    s_barrier
    s_waitcnt vmcnt(7)
    s_barrier
    s_barrier
    s_mov_b32 s35, 0x10000
    s_waitcnt vmcnt(6)
A_pollx:
    v_cmp_eq_u32 vcc, 0, v37
    s_cbranch_vccz A_pollxx
    buffer_load_dwordx2 v[36:37], v4, s[16:19], s33 offen sc1
    s_waitcnt vmcnt(0)
    s_sub_u32 s35, s35, 1
    s_cbranch_scc0 A_pollx
A_pollxx:
    ds_write_b64 v4, v[36:37]
    ds_write_b32 v2, v37 offset:1024
    s_waitcnt lgkmcnt(0)
    s_barrier
    s_branch F_entry
A_comp:
    s_getpc_b64 s[60:61]
A_pc:
    s_sub_u32 s60, s60, A_pc-sequential_preLN__mha_block__dense_activation_squared_relu__prompt_kernel
    s_subb_u32 s61, s61, 0
    s_bfe_u32 s32, s2, 0x30003
    s_lshl2_add_u32 s32, s32, s20
    s_lshl_b32 s32, s32, 11
    v_lshl_add_u32 v3, v1, 7, s32
    v_min_u32 v3, code_end-sequential_preLN__mha_block__dense_activation_squared_relu__prompt_kernel-4, v3
    s_mov_b64 exec, 0xffff
    global_load_dword v6, v3, s[60:61]
    s_mov_b64 exec, -1
    s_lshr_b32 s21, s20, 1
    s_and_b32 s22, s20, 1
    v_and_b32 v2, 31, v1
    v_lshrrev_b32 v3, 5, v1
    v_bfe_u32 v4, v1, 1, 3
    v_xor_b32 v4, v4, v3
    s_lshl_b32 s32, s21, 13
    v_lshl_add_u32 v2, v2, 7, s32
    s_lshl_b32 s33, s21, 2
    v_xor_b32 v4, s33, v4
    v_xor_b32 v5, 0, v4
    v_lshl_add_u32 v7, v5, 4, v2
    v_xor_b32 v5, 2, v4
    v_lshl_add_u32 v8, v5, 4, v2
    v_xor_b32 v5, 4, v4
    v_lshl_add_u32 v9, v5, 4, v2
    v_xor_b32 v5, 6, v4
    v_lshl_add_u32 v10, v5, 4, v2
    v_lshlrev_b32 v2, 11, v3
    v_bfe_u32 v4, v1, 2, 2
    v_lshl_add_u32 v2, v4, 6, v2
    v_bfe_u32 v4, v1, 4, 1
    v_lshl_add_u32 v2, v4, 5, v2
    v_and_b32 v4, 3, v1
    v_lshl_add_u32 v2, v4, 3, v2
    s_lshl_b32 s33, s22, 9
    s_add_u32 s33, s33, s32
    s_add_u32 s33, s33, 16384
    v_add_u32 v11, s33, v2
    v_xor_b32 v12, 0x2000, v11
    v_mov_b32 v84, 0
    v_mov_b32 v85, 0
    v_mov_b32 v86, 0
    v_mov_b32 v87, 0
    v_mov_b32 v88, 0
    v_mov_b32 v89, 0
    v_mov_b32 v90, 0
    v_mov_b32 v91, 0
    v_mov_b32 v92, 0
    v_mov_b32 v93, 0
    v_mov_b32 v94, 0
    v_mov_b32 v95, 0
    v_mov_b32 v96, 0
    v_mov_b32 v97, 0
    v_mov_b32 v98, 0
    v_mov_b32 v99, 0
    v_mov_b32 v100, 0
    v_mov_b32 v101, 0
    v_mov_b32 v102, 0
    v_mov_b32 v103, 0
    v_mov_b32 v104, 0
    v_mov_b32 v105, 0
    v_mov_b32 v106, 0
    v_mov_b32 v107, 0
    v_mov_b32 v108, 0
    v_mov_b32 v109, 0
    v_mov_b32 v110, 0
    v_mov_b32 v111, 0
    v_mov_b32 v112, 0
    v_mov_b32 v113, 0
    v_mov_b32 v114, 0
    v_mov_b32 v115, 0
    v_mov_b32 v116, 0
    v_mov_b32 v117, 0
    v_mov_b32 v118, 0
    v_mov_b32 v119, 0
    v_mov_b32 v120, 0
    v_mov_b32 v121, 0
    v_mov_b32 v122, 0
    v_mov_b32 v123, 0
    v_mov_b32 v124, 0
    v_mov_b32 v125, 0
    v_mov_b32 v126, 0
    v_mov_b32 v127, 0
    v_mov_b32 v128, 0
    v_mov_b32 v129, 0
    v_mov_b32 v130, 0
    v_mov_b32 v131, 0
    v_mov_b32 v132, 0
    v_mov_b32 v133, 0
    v_mov_b32 v134, 0
    v_mov_b32 v135, 0
    v_mov_b32 v136, 0
    v_mov_b32 v137, 0
    v_mov_b32 v138, 0
    v_mov_b32 v139, 0
    v_mov_b32 v140, 0
    v_mov_b32 v141, 0
    v_mov_b32 v142, 0
    v_mov_b32 v143, 0
    v_mov_b32 v144, 0
    v_mov_b32 v145, 0
    v_mov_b32 v146, 0
    v_mov_b32 v147, 0
    v_mov_b32 v13, 0
    v_mov_b32 v14, 0
    v_mov_b32 v15, 0
    v_mov_b32 v16, 0
    s_mov_b32 s38, 0x3f803f80
    s_mov_b32 s39, 0xfffe0000
    s_mov_b32 s26, 0
    s_mov_b32 s35, 0x8000
    s_mov_b32 s36, 0x8000
    s_mov_b32 s37, 0
    s_waitcnt lgkmcnt(0)
    s_mov_b32 s18, 0x2000000
    s_mov_b32 s19, 0x20000
    s_barrier
    ds_read_b128 v[20:23], v7
    ds_read_b64_tr_b16 v[52:53], v11 offset:0
    ds_read_b64_tr_b16 v[54:55], v11 offset:1024
    ds_read_b128 v[24:27], v7 offset:4096
    ds_read_b64_tr_b16 v[56:57], v11 offset:256
    ds_read_b64_tr_b16 v[58:59], v11 offset:1280
    ds_read_b128 v[28:31], v8
    ds_read_b64_tr_b16 v[60:61], v11 offset:4096
    ds_read_b64_tr_b16 v[62:63], v11 offset:5120
    ds_read_b128 v[32:35], v8 offset:4096
    ds_read_b64_tr_b16 v[64:65], v11 offset:4352
    ds_read_b64_tr_b16 v[66:67], v11 offset:5376
    v_add_u32 v7, 0x8000, v7
    v_add_u32 v8, 0x8000, v8
    v_add_u32 v11, 0x8000, v11
    s_waitcnt lgkmcnt(6)
    s_cmp_ge_u32 s24, 10
    s_cbranch_scc1 A_loopV
.p2align 6
A_loopQ:
    v_mfma_f32_32x32x16_bf16 v[84:99], v[52:55], v[20:23], v[84:99]
    ds_read_b128 v[36:39], v9
    ds_read_b64_tr_b16 v[68:69], v12 offset:0
    v_mfma_f32_32x32x16_bf16 v[100:115], v[52:55], v[24:27], v[100:115]
    ds_read_b64_tr_b16 v[70:71], v12 offset:1024
    ds_read_b128 v[40:43], v9 offset:4096
    v_mfma_f32_32x32x16_bf16 v[116:131], v[56:59], v[20:23], v[116:131]
    ds_read_b64_tr_b16 v[72:73], v12 offset:256
    ds_read_b64_tr_b16 v[74:75], v12 offset:1280
    v_mfma_f32_32x32x16_bf16 v[132:147], v[56:59], v[24:27], v[132:147]
    v_add_u32 v9, s35, v9
    s_add_u32 s37, s37, 1
    s_add_u32 s26, s26, 1
    s_waitcnt lgkmcnt(6)
    v_mfma_f32_32x32x16_bf16 v[84:99], v[60:63], v[28:31], v[84:99]
    ds_read_b128 v[44:47], v10
    ds_read_b64_tr_b16 v[76:77], v12 offset:4096
    v_mfma_f32_32x32x16_bf16 v[100:115], v[60:63], v[32:35], v[100:115]
    ds_read_b64_tr_b16 v[78:79], v12 offset:5120
    ds_read_b128 v[48:51], v10 offset:4096
    v_mfma_f32_32x32x16_bf16 v[116:131], v[64:67], v[28:31], v[116:131]
    ds_read_b64_tr_b16 v[80:81], v12 offset:4352
    ds_read_b64_tr_b16 v[82:83], v12 offset:5376
    v_mfma_f32_32x32x16_bf16 v[132:147], v[64:67], v[32:35], v[132:147]
    v_add_u32 v10, s35, v10
    v_add_u32 v12, s35, v12
    s_mov_b32 s35, s36
    s_waitcnt lgkmcnt(6)
    v_dot2_f32_bf16 v13, v52, s38, v13
    v_dot2_f32_bf16 v15, v56, s38, v15
    v_dot2_f32_bf16 v14, v53, s38, v14
    v_dot2_f32_bf16 v16, v57, s38, v16
    v_dot2_f32_bf16 v13, v54, s38, v13
    v_dot2_f32_bf16 v15, v58, s38, v15
    v_dot2_f32_bf16 v14, v55, s38, v14
    v_dot2_f32_bf16 v16, v59, s38, v16
    v_dot2_f32_bf16 v13, v60, s38, v13
    v_dot2_f32_bf16 v15, v64, s38, v15
    v_dot2_f32_bf16 v14, v61, s38, v14
    v_dot2_f32_bf16 v16, v65, s38, v16
    v_dot2_f32_bf16 v13, v62, s38, v13
    v_dot2_f32_bf16 v15, v66, s38, v15
    v_dot2_f32_bf16 v14, v63, s38, v14
    v_dot2_f32_bf16 v16, v67, s38, v16
    v_mfma_f32_32x32x16_bf16 v[84:99], v[68:71], v[36:39], v[84:99]
    s_barrier
    ds_read_b128 v[20:23], v7
    ds_read_b64_tr_b16 v[52:53], v11 offset:0
    v_mfma_f32_32x32x16_bf16 v[100:115], v[68:71], v[40:43], v[100:115]
    ds_read_b64_tr_b16 v[54:55], v11 offset:1024
    ds_read_b128 v[24:27], v7 offset:4096
    v_mfma_f32_32x32x16_bf16 v[116:131], v[72:75], v[36:39], v[116:131]
    ds_read_b64_tr_b16 v[56:57], v11 offset:256
    ds_read_b64_tr_b16 v[58:59], v11 offset:1280
    v_mfma_f32_32x32x16_bf16 v[132:147], v[72:75], v[40:43], v[132:147]
    v_add_u32 v7, s36, v7
    s_cmp_eq_u32 s37, 3
    s_cselect_b32 s43, s39, 0x8000
    s_cselect_b32 s37, -2, s37
    s_waitcnt lgkmcnt(6)
    v_mfma_f32_32x32x16_bf16 v[84:99], v[76:79], v[44:47], v[84:99]
    ds_read_b128 v[28:31], v8
    ds_read_b64_tr_b16 v[60:61], v11 offset:4096
    v_mfma_f32_32x32x16_bf16 v[100:115], v[76:79], v[48:51], v[100:115]
    ds_read_b64_tr_b16 v[62:63], v11 offset:5120
    ds_read_b128 v[32:35], v8 offset:4096
    v_mfma_f32_32x32x16_bf16 v[116:131], v[80:83], v[44:47], v[116:131]
    ds_read_b64_tr_b16 v[64:65], v11 offset:4352
    ds_read_b64_tr_b16 v[66:67], v11 offset:5376
    v_mfma_f32_32x32x16_bf16 v[132:147], v[80:83], v[48:51], v[132:147]
    v_add_u32 v8, s36, v8
    v_add_u32 v11, s36, v11
    s_mov_b32 s36, s43
    s_cmp_lt_u32 s26, 10
    s_waitcnt lgkmcnt(6)
    s_cbranch_scc1 A_loopQ
    v_add_f32 v13, v13, v14
    v_add_f32 v15, v15, v16
    s_lshl_b32 s33, s20, 8
    v_lshl_add_u32 v3, v1, 2, s33
    v_permlane32_swap_b32 v13, v15
    v_add_f32 v13, v13, v15
    s_waitcnt lgkmcnt(0)
    ds_write_b32 v3, v13 offset:2048
    v_xor_b32 v3, 512, v3
    v_and_b32 v2, 31, v1
    v_lshrrev_b32 v4, 5, v1
    s_lshl_b32 s32, s21, 9
    v_lshl_add_u32 v5, v2, 3, s32
    s_waitcnt lgkmcnt(0)
    s_barrier
    ds_read_b32 v15, v3 offset:2048
    ds_read_b64 v[180:181], v5 offset:0
    ds_read_b64 v[182:183], v5 offset:256
    v_mov_b32 v22, 0
    v_mov_b32 v23, 0
    v_mov_b32 v26, 0
    v_mov_b32 v27, 0
    v_mov_b32 v54, 0
    v_mov_b32 v55, 0
    v_mov_b32 v58, 0
    v_mov_b32 v59, 0
    s_mov_b32 s40, -1
    s_mov_b32 s41, 0
    s_waitcnt lgkmcnt(0)
    v_add_f32 v13, v13, v15
    v_mov_b32 v15, v13
    v_cndmask_b32 v180, 0, v180, s[40:41]
    v_cvt_pk_bf16_f32 v21, v180, 0
    v_lshlrev_b32 v5, 16, v21
    v_sub_f32 v5, v180, v5
    v_cvt_pk_bf16_f32 v20, v180, v5
    v_cndmask_b32 v182, 0, v182, s[40:41]
    v_cvt_pk_bf16_f32 v25, v182, 0
    v_lshlrev_b32 v5, 16, v25
    v_sub_f32 v5, v182, v5
    v_cvt_pk_bf16_f32 v24, v182, v5
    v_permlane32_swap_b32 v13, v15
    v_cvt_pk_bf16_f32 v52, v13, v13
    v_and_b32 v5, 0xffff0000, v52
    v_sub_f32 v5, v13, v5
    v_cvt_pk_bf16_f32 v53, v5, 0
    v_cvt_pk_bf16_f32 v56, v15, v15
    v_and_b32 v5, 0xffff0000, v56
    v_sub_f32 v5, v15, v5
    v_cvt_pk_bf16_f32 v57, v5, 0
    v_mfma_f32_32x32x16_bf16 v[84:99], v[52:55], v[20:23], v[84:99]
    v_mfma_f32_32x32x16_bf16 v[100:115], v[52:55], v[24:27], v[100:115]
    v_mfma_f32_32x32x16_bf16 v[116:131], v[56:59], v[20:23], v[116:131]
    v_mfma_f32_32x32x16_bf16 v[132:147], v[56:59], v[24:27], v[132:147]
    v_lshlrev_b32 v2, 4, v2
    s_cmp_lt_u32 s24, 5
    s_mov_b32 s32, 0x3ea52b5c
    s_cselect_b32 s32, s32, 1.0
    v_mul_f32 v181, s32, v181
    v_mul_f32 v183, s32, v183
    v_lshl_add_u32 v2, v4, 14, v2
    s_lshl1_add_u32 s32, s24, s22
    s_lshl_b32 s32, s32, 18
    s_lshl1_add_u32 s33, s23, s21
    s_lshl_b32 s33, s33, 9
    s_add_u32 s32, s32, s33
    v_pk_mul_f32 v[84:85], v[84:85], v[180:181] op_sel:[0,1]
    v_pk_mul_f32 v[86:87], v[86:87], v[180:181] op_sel:[0,1]
    v_cvt_pk_bf16_f32 v28, v84, v85
    v_cvt_pk_bf16_f32 v29, v86, v87
    v_pk_mul_f32 v[100:101], v[100:101], v[182:183] op_sel:[0,1]
    v_pk_mul_f32 v[102:103], v[102:103], v[182:183] op_sel:[0,1]
    v_cvt_pk_bf16_f32 v30, v100, v101
    v_cvt_pk_bf16_f32 v31, v102, v103
    buffer_store_dwordx4 v[28:31], v2, s[16:19], s32 offen sc1
    s_add_u32 s32, s32, 32768
    v_pk_mul_f32 v[88:89], v[88:89], v[180:181] op_sel:[0,1]
    v_pk_mul_f32 v[90:91], v[90:91], v[180:181] op_sel:[0,1]
    v_cvt_pk_bf16_f32 v32, v88, v89
    v_cvt_pk_bf16_f32 v33, v90, v91
    v_pk_mul_f32 v[104:105], v[104:105], v[182:183] op_sel:[0,1]
    v_pk_mul_f32 v[106:107], v[106:107], v[182:183] op_sel:[0,1]
    v_cvt_pk_bf16_f32 v34, v104, v105
    v_cvt_pk_bf16_f32 v35, v106, v107
    buffer_store_dwordx4 v[32:35], v2, s[16:19], s32 offen sc1
    s_add_u32 s32, s32, 32768
    v_pk_mul_f32 v[92:93], v[92:93], v[180:181] op_sel:[0,1]
    v_pk_mul_f32 v[94:95], v[94:95], v[180:181] op_sel:[0,1]
    v_cvt_pk_bf16_f32 v36, v92, v93
    v_cvt_pk_bf16_f32 v37, v94, v95
    v_pk_mul_f32 v[108:109], v[108:109], v[182:183] op_sel:[0,1]
    v_pk_mul_f32 v[110:111], v[110:111], v[182:183] op_sel:[0,1]
    v_cvt_pk_bf16_f32 v38, v108, v109
    v_cvt_pk_bf16_f32 v39, v110, v111
    buffer_store_dwordx4 v[36:39], v2, s[16:19], s32 offen sc1
    s_add_u32 s32, s32, 32768
    v_pk_mul_f32 v[96:97], v[96:97], v[180:181] op_sel:[0,1]
    v_pk_mul_f32 v[98:99], v[98:99], v[180:181] op_sel:[0,1]
    v_cvt_pk_bf16_f32 v40, v96, v97
    v_cvt_pk_bf16_f32 v41, v98, v99
    v_pk_mul_f32 v[112:113], v[112:113], v[182:183] op_sel:[0,1]
    v_pk_mul_f32 v[114:115], v[114:115], v[182:183] op_sel:[0,1]
    v_cvt_pk_bf16_f32 v42, v112, v113
    v_cvt_pk_bf16_f32 v43, v114, v115
    buffer_store_dwordx4 v[40:43], v2, s[16:19], s32 offen sc1
    s_add_u32 s32, s32, 32768
    v_pk_mul_f32 v[116:117], v[116:117], v[180:181] op_sel:[0,1]
    v_pk_mul_f32 v[118:119], v[118:119], v[180:181] op_sel:[0,1]
    v_cvt_pk_bf16_f32 v44, v116, v117
    v_cvt_pk_bf16_f32 v45, v118, v119
    v_pk_mul_f32 v[132:133], v[132:133], v[182:183] op_sel:[0,1]
    v_pk_mul_f32 v[134:135], v[134:135], v[182:183] op_sel:[0,1]
    v_cvt_pk_bf16_f32 v46, v132, v133
    v_cvt_pk_bf16_f32 v47, v134, v135
    buffer_store_dwordx4 v[44:47], v2, s[16:19], s32 offen sc1
    s_add_u32 s32, s32, 32768
    v_pk_mul_f32 v[120:121], v[120:121], v[180:181] op_sel:[0,1]
    v_pk_mul_f32 v[122:123], v[122:123], v[180:181] op_sel:[0,1]
    v_cvt_pk_bf16_f32 v48, v120, v121
    v_cvt_pk_bf16_f32 v49, v122, v123
    v_pk_mul_f32 v[136:137], v[136:137], v[182:183] op_sel:[0,1]
    v_pk_mul_f32 v[138:139], v[138:139], v[182:183] op_sel:[0,1]
    v_cvt_pk_bf16_f32 v50, v136, v137
    v_cvt_pk_bf16_f32 v51, v138, v139
    buffer_store_dwordx4 v[48:51], v2, s[16:19], s32 offen sc1
    s_add_u32 s32, s32, 32768
    v_pk_mul_f32 v[124:125], v[124:125], v[180:181] op_sel:[0,1]
    v_pk_mul_f32 v[126:127], v[126:127], v[180:181] op_sel:[0,1]
    v_cvt_pk_bf16_f32 v60, v124, v125
    v_cvt_pk_bf16_f32 v61, v126, v127
    v_pk_mul_f32 v[140:141], v[140:141], v[182:183] op_sel:[0,1]
    v_pk_mul_f32 v[142:143], v[142:143], v[182:183] op_sel:[0,1]
    v_cvt_pk_bf16_f32 v62, v140, v141
    v_cvt_pk_bf16_f32 v63, v142, v143
    buffer_store_dwordx4 v[60:63], v2, s[16:19], s32 offen sc1
    s_add_u32 s32, s32, 32768
    v_pk_mul_f32 v[128:129], v[128:129], v[180:181] op_sel:[0,1]
    v_pk_mul_f32 v[130:131], v[130:131], v[180:181] op_sel:[0,1]
    v_cvt_pk_bf16_f32 v64, v128, v129
    v_cvt_pk_bf16_f32 v65, v130, v131
    v_pk_mul_f32 v[144:145], v[144:145], v[182:183] op_sel:[0,1]
    v_pk_mul_f32 v[146:147], v[146:147], v[182:183] op_sel:[0,1]
    v_cvt_pk_bf16_f32 v66, v144, v145
    v_cvt_pk_bf16_f32 v67, v146, v147
    buffer_store_dwordx4 v[64:67], v2, s[16:19], s32 offen sc1
    s_add_u32 s32, s32, 32768
    s_branch A_sig
.p2align 6
A_loopV:
    v_mfma_f32_32x32x16_bf16 v[84:99], v[20:23], v[52:55], v[84:99]
    ds_read_b128 v[36:39], v9
    ds_read_b64_tr_b16 v[68:69], v12 offset:0
    v_mfma_f32_32x32x16_bf16 v[100:115], v[24:27], v[52:55], v[100:115]
    ds_read_b64_tr_b16 v[70:71], v12 offset:1024
    ds_read_b128 v[40:43], v9 offset:4096
    v_mfma_f32_32x32x16_bf16 v[116:131], v[20:23], v[56:59], v[116:131]
    ds_read_b64_tr_b16 v[72:73], v12 offset:256
    ds_read_b64_tr_b16 v[74:75], v12 offset:1280
    v_mfma_f32_32x32x16_bf16 v[132:147], v[24:27], v[56:59], v[132:147]
    v_add_u32 v9, s35, v9
    s_add_u32 s37, s37, 1
    s_add_u32 s26, s26, 1
    s_waitcnt lgkmcnt(6)
    v_mfma_f32_32x32x16_bf16 v[84:99], v[28:31], v[60:63], v[84:99]
    ds_read_b128 v[44:47], v10
    ds_read_b64_tr_b16 v[76:77], v12 offset:4096
    v_mfma_f32_32x32x16_bf16 v[100:115], v[32:35], v[60:63], v[100:115]
    ds_read_b64_tr_b16 v[78:79], v12 offset:5120
    ds_read_b128 v[48:51], v10 offset:4096
    v_mfma_f32_32x32x16_bf16 v[116:131], v[28:31], v[64:67], v[116:131]
    ds_read_b64_tr_b16 v[80:81], v12 offset:4352
    ds_read_b64_tr_b16 v[82:83], v12 offset:5376
    v_mfma_f32_32x32x16_bf16 v[132:147], v[32:35], v[64:67], v[132:147]
    v_add_u32 v10, s35, v10
    v_add_u32 v12, s35, v12
    s_mov_b32 s35, s36
    s_waitcnt lgkmcnt(6)
    v_dot2_f32_bf16 v13, v52, s38, v13
    v_dot2_f32_bf16 v15, v56, s38, v15
    v_dot2_f32_bf16 v14, v53, s38, v14
    v_dot2_f32_bf16 v16, v57, s38, v16
    v_dot2_f32_bf16 v13, v54, s38, v13
    v_dot2_f32_bf16 v15, v58, s38, v15
    v_dot2_f32_bf16 v14, v55, s38, v14
    v_dot2_f32_bf16 v16, v59, s38, v16
    v_dot2_f32_bf16 v13, v60, s38, v13
    v_dot2_f32_bf16 v15, v64, s38, v15
    v_dot2_f32_bf16 v14, v61, s38, v14
    v_dot2_f32_bf16 v16, v65, s38, v16
    v_dot2_f32_bf16 v13, v62, s38, v13
    v_dot2_f32_bf16 v15, v66, s38, v15
    v_dot2_f32_bf16 v14, v63, s38, v14
    v_dot2_f32_bf16 v16, v67, s38, v16
    v_mfma_f32_32x32x16_bf16 v[84:99], v[36:39], v[68:71], v[84:99]
    s_barrier
    ds_read_b128 v[20:23], v7
    ds_read_b64_tr_b16 v[52:53], v11 offset:0
    v_mfma_f32_32x32x16_bf16 v[100:115], v[40:43], v[68:71], v[100:115]
    ds_read_b64_tr_b16 v[54:55], v11 offset:1024
    ds_read_b128 v[24:27], v7 offset:4096
    v_mfma_f32_32x32x16_bf16 v[116:131], v[36:39], v[72:75], v[116:131]
    ds_read_b64_tr_b16 v[56:57], v11 offset:256
    ds_read_b64_tr_b16 v[58:59], v11 offset:1280
    v_mfma_f32_32x32x16_bf16 v[132:147], v[40:43], v[72:75], v[132:147]
    v_add_u32 v7, s36, v7
    s_cmp_eq_u32 s37, 3
    s_cselect_b32 s43, s39, 0x8000
    s_cselect_b32 s37, -2, s37
    s_waitcnt lgkmcnt(6)
    v_mfma_f32_32x32x16_bf16 v[84:99], v[44:47], v[76:79], v[84:99]
    ds_read_b128 v[28:31], v8
    ds_read_b64_tr_b16 v[60:61], v11 offset:4096
    v_mfma_f32_32x32x16_bf16 v[100:115], v[48:51], v[76:79], v[100:115]
    ds_read_b64_tr_b16 v[62:63], v11 offset:5120
    ds_read_b128 v[32:35], v8 offset:4096
    v_mfma_f32_32x32x16_bf16 v[116:131], v[44:47], v[80:83], v[116:131]
    ds_read_b64_tr_b16 v[64:65], v11 offset:4352
    ds_read_b64_tr_b16 v[66:67], v11 offset:5376
    v_mfma_f32_32x32x16_bf16 v[132:147], v[48:51], v[80:83], v[132:147]
    v_add_u32 v8, s36, v8
    v_add_u32 v11, s36, v11
    s_mov_b32 s36, s43
    s_cmp_lt_u32 s26, 10
    s_waitcnt lgkmcnt(6)
    s_cbranch_scc1 A_loopV
    v_add_f32 v13, v13, v14
    v_add_f32 v15, v15, v16
    s_lshl_b32 s33, s20, 8
    v_lshl_add_u32 v3, v1, 2, s33
    v_permlane32_swap_b32 v13, v15
    v_add_f32 v13, v13, v15
    s_waitcnt lgkmcnt(0)
    ds_write_b32 v3, v13 offset:2048
    v_xor_b32 v3, 512, v3
    v_and_b32 v2, 31, v1
    v_lshrrev_b32 v4, 5, v1
    s_lshl_b32 s32, s21, 9
    v_lshl_add_u32 v5, v2, 3, s32
    s_waitcnt lgkmcnt(0)
    s_barrier
    ds_read_b32 v15, v3 offset:2048
    ds_read_b64 v[180:181], v5 offset:0
    ds_read_b64 v[182:183], v5 offset:256
    s_lshl_b32 s32, s21, 8
    v_lshl_add_u32 v3, v4, 4, s32
    ds_read_b128 v[148:151], v3 offset:1024
    ds_read_b128 v[152:155], v3 offset:1056
    ds_read_b128 v[156:159], v3 offset:1088
    ds_read_b128 v[160:163], v3 offset:1120
    ds_read_b128 v[164:167], v3 offset:1152
    ds_read_b128 v[168:171], v3 offset:1184
    ds_read_b128 v[172:175], v3 offset:1216
    ds_read_b128 v[176:179], v3 offset:1248
    v_mov_b32 v22, 0
    v_mov_b32 v23, 0
    v_mov_b32 v26, 0
    v_mov_b32 v27, 0
    v_mov_b32 v54, 0
    v_mov_b32 v55, 0
    v_mov_b32 v58, 0
    v_mov_b32 v59, 0
    s_mov_b32 s40, -1
    s_mov_b32 s41, 0
    s_waitcnt lgkmcnt(8)
    v_add_f32 v13, v13, v15
    v_mov_b32 v15, v13
    v_cndmask_b32 v180, 0, v180, s[40:41]
    v_cvt_pk_bf16_f32 v21, v180, 0
    v_lshlrev_b32 v5, 16, v21
    v_sub_f32 v5, v180, v5
    v_cvt_pk_bf16_f32 v20, v180, v5
    v_cndmask_b32 v182, 0, v182, s[40:41]
    v_cvt_pk_bf16_f32 v25, v182, 0
    v_lshlrev_b32 v5, 16, v25
    v_sub_f32 v5, v182, v5
    v_cvt_pk_bf16_f32 v24, v182, v5
    v_permlane32_swap_b32 v13, v15
    v_cvt_pk_bf16_f32 v52, v13, v13
    v_and_b32 v5, 0xffff0000, v52
    v_sub_f32 v5, v13, v5
    v_cvt_pk_bf16_f32 v53, v5, 0
    v_cvt_pk_bf16_f32 v56, v15, v15
    v_and_b32 v5, 0xffff0000, v56
    v_sub_f32 v5, v15, v5
    v_cvt_pk_bf16_f32 v57, v5, 0
    v_mfma_f32_32x32x16_bf16 v[84:99], v[20:23], v[52:55], v[84:99]
    v_mfma_f32_32x32x16_bf16 v[100:115], v[24:27], v[52:55], v[100:115]
    v_mfma_f32_32x32x16_bf16 v[116:131], v[20:23], v[56:59], v[116:131]
    v_mfma_f32_32x32x16_bf16 v[132:147], v[24:27], v[56:59], v[132:147]
    v_lshlrev_b32 v2, 4, v2
    v_mul_u32_u24 v4, 10240, v4
    v_add_u32 v2, v2, v4
    s_lshl1_add_u32 s32, s23, s21
    s_mul_i32 s32, s32, 81920
    s_lshl1_add_u32 s33, s24, s22
    s_lshl_b32 s33, s33, 10
    s_add_u32 s32, s32, s33
    s_waitcnt lgkmcnt(0)
    v_pk_mul_f32 v[84:85], v[84:85], v[148:149]
    v_pk_mul_f32 v[86:87], v[86:87], v[150:151]
    v_pk_mul_f32 v[88:89], v[88:89], v[152:153]
    v_pk_mul_f32 v[90:91], v[90:91], v[154:155]
    v_cvt_pk_bf16_f32 v28, v84, v85
    v_cvt_pk_bf16_f32 v29, v86, v87
    v_cvt_pk_bf16_f32 v30, v88, v89
    v_cvt_pk_bf16_f32 v31, v90, v91
    s_add_u32 s33, s32, 5222400
    buffer_store_dwordx4 v[28:31], v2, s[16:19], s33 offen sc1
    v_pk_mul_f32 v[92:93], v[92:93], v[156:157]
    v_pk_mul_f32 v[94:95], v[94:95], v[158:159]
    v_pk_mul_f32 v[96:97], v[96:97], v[160:161]
    v_pk_mul_f32 v[98:99], v[98:99], v[162:163]
    v_cvt_pk_bf16_f32 v32, v92, v93
    v_cvt_pk_bf16_f32 v33, v94, v95
    v_cvt_pk_bf16_f32 v34, v96, v97
    v_cvt_pk_bf16_f32 v35, v98, v99
    s_add_u32 s33, s32, 5242880
    buffer_store_dwordx4 v[32:35], v2, s[16:19], s33 offen sc1
    v_pk_mul_f32 v[100:101], v[100:101], v[164:165]
    v_pk_mul_f32 v[102:103], v[102:103], v[166:167]
    v_pk_mul_f32 v[104:105], v[104:105], v[168:169]
    v_pk_mul_f32 v[106:107], v[106:107], v[170:171]
    v_cvt_pk_bf16_f32 v36, v100, v101
    v_cvt_pk_bf16_f32 v37, v102, v103
    v_cvt_pk_bf16_f32 v38, v104, v105
    v_cvt_pk_bf16_f32 v39, v106, v107
    s_add_u32 s33, s32, 5263360
    buffer_store_dwordx4 v[36:39], v2, s[16:19], s33 offen sc1
    v_pk_mul_f32 v[108:109], v[108:109], v[172:173]
    v_pk_mul_f32 v[110:111], v[110:111], v[174:175]
    v_pk_mul_f32 v[112:113], v[112:113], v[176:177]
    v_pk_mul_f32 v[114:115], v[114:115], v[178:179]
    v_cvt_pk_bf16_f32 v40, v108, v109
    v_cvt_pk_bf16_f32 v41, v110, v111
    v_cvt_pk_bf16_f32 v42, v112, v113
    v_cvt_pk_bf16_f32 v43, v114, v115
    s_add_u32 s33, s32, 5283840
    buffer_store_dwordx4 v[40:43], v2, s[16:19], s33 offen sc1
    v_pk_mul_f32 v[116:117], v[116:117], v[148:149]
    v_pk_mul_f32 v[118:119], v[118:119], v[150:151]
    v_pk_mul_f32 v[120:121], v[120:121], v[152:153]
    v_pk_mul_f32 v[122:123], v[122:123], v[154:155]
    v_cvt_pk_bf16_f32 v44, v116, v117
    v_cvt_pk_bf16_f32 v45, v118, v119
    v_cvt_pk_bf16_f32 v46, v120, v121
    v_cvt_pk_bf16_f32 v47, v122, v123
    s_add_u32 s33, s32, 5222912
    buffer_store_dwordx4 v[44:47], v2, s[16:19], s33 offen sc1
    v_pk_mul_f32 v[124:125], v[124:125], v[156:157]
    v_pk_mul_f32 v[126:127], v[126:127], v[158:159]
    v_pk_mul_f32 v[128:129], v[128:129], v[160:161]
    v_pk_mul_f32 v[130:131], v[130:131], v[162:163]
    v_cvt_pk_bf16_f32 v48, v124, v125
    v_cvt_pk_bf16_f32 v49, v126, v127
    v_cvt_pk_bf16_f32 v50, v128, v129
    v_cvt_pk_bf16_f32 v51, v130, v131
    s_add_u32 s33, s32, 5243392
    buffer_store_dwordx4 v[48:51], v2, s[16:19], s33 offen sc1
    v_pk_mul_f32 v[132:133], v[132:133], v[164:165]
    v_pk_mul_f32 v[134:135], v[134:135], v[166:167]
    v_pk_mul_f32 v[136:137], v[136:137], v[168:169]
    v_pk_mul_f32 v[138:139], v[138:139], v[170:171]
    v_cvt_pk_bf16_f32 v60, v132, v133
    v_cvt_pk_bf16_f32 v61, v134, v135
    v_cvt_pk_bf16_f32 v62, v136, v137
    v_cvt_pk_bf16_f32 v63, v138, v139
    s_add_u32 s33, s32, 5263872
    buffer_store_dwordx4 v[60:63], v2, s[16:19], s33 offen sc1
    v_pk_mul_f32 v[140:141], v[140:141], v[172:173]
    v_pk_mul_f32 v[142:143], v[142:143], v[174:175]
    v_pk_mul_f32 v[144:145], v[144:145], v[176:177]
    v_pk_mul_f32 v[146:147], v[146:147], v[178:179]
    v_cvt_pk_bf16_f32 v64, v140, v141
    v_cvt_pk_bf16_f32 v65, v142, v143
    v_cvt_pk_bf16_f32 v66, v144, v145
    v_cvt_pk_bf16_f32 v67, v146, v147
    s_add_u32 s33, s32, 5284352
    buffer_store_dwordx4 v[64:67], v2, s[16:19], s33 offen sc1
A_sig:
    s_lshl4_add_u32 s32, s24, s23
    s_lshl_b32 s32, s32, 7
    s_lshl2_add_u32 s32, s20, s32
    s_add_u32 s70, s32, 19496960
    s_branch A_nort
A_nofl:
    s_mov_b32 s70, 0x40000000
A_nort:
    s_mov_b32 s3, 0x40000000
    s_mov_b32 s71, 40
    s_branch F_entry
A_aux:
    v_lshrrev_b32 v2, 3, v1
    v_mul_u32_u24 v3, 1280, v2
    v_and_b32 v4, 7, v1
    v_lshl_add_u32 v3, v4, 4, v3
    s_lshl3_add_u32 s27, s23, s20
    s_mul_i32 s32, s27, 20480
    s_add_u32 s29, s32, 10240
    s_mov_b32 s38, 0x3f803f80
    s_lshl_b32 s33, s23, 13
    s_add_u32 s33, s33, 19464192
    s_lshl_b32 s30, s27, 7
    s_add_u32 s30, s30, 19791872
    v_lshlrev_b32 v5, 4, v0
    v_lshlrev_b32 v4, 4, v1
    v_mov_b32 v8, 0
    v_mov_b32 v9, 0
    v_mov_b32 v10, 0
    v_mov_b32 v11, 0
    v_mov_b32 v12, 0
    v_mov_b32 v13, 0
    v_mov_b32 v14, 0
    v_mov_b32 v15, 0
    s_waitcnt lgkmcnt(0)
    s_mov_b32 s10, 0x280000
    s_mov_b32 s11, 0x20000
    s_mov_b32 s18, 0x2000000
    s_mov_b32 s19, 0x20000
    s_mov_b32 s66, 0x100
    s_mov_b32 s67, 0x20000
    buffer_store_dwordx4 v[12:15], v5, s[16:19], s33 offen sc1
    s_mov_b64 exec, 0xff
    buffer_store_dwordx4 v[12:15], v4, s[16:19], s30 offen sc1
    s_mov_b64 exec, -1
    s_mov_b32 s46, 0x1e0000
    s_mov_b32 s47, 0x20000
    s_mov_b32 s58, 0xc00
    s_mov_b32 s59, 0x20000
    s_mov_b32 s35, 0x15555556
    v_mul_hi_u32 v6, s35, v0
    v_mul_u32_u24 v6, 2880, v6
    v_lshl_add_u32 v6, v0, 4, v6
    s_movk_i32 s35, 480
    v_cmp_le_u32 s[40:41], s35, v0
    v_mov_b32 v5, 0x40000000
    s_nop 0
    v_cndmask_b32 v6, v6, v5, s[40:41]
    s_mul_i32 s28, s23, 192
    buffer_load_dwordx4 v[96:99], v6, s[44:47], s28 offen
    s_add_u32 s28, s28, 122880
    buffer_load_dwordx4 v[100:103], v6, s[44:47], s28 offen
    s_add_u32 s28, s28, 122880
    buffer_load_dwordx4 v[104:107], v6, s[44:47], s28 offen
    s_add_u32 s28, s28, 122880
    s_lshl_b32 s33, s23, 2
    s_cmp_eq_u32 s20, 7
    s_cselect_b32 s33, s33, 0x1000
    v_mov_b32 v5, 1
    s_waitcnt vmcnt(3)
    s_barrier
    s_mov_b64 exec, 1
    buffer_store_dword v5, v4, s[64:67], s33 offen sc1
    s_mov_b64 exec, -1
    buffer_load_dwordx4 v[108:111], v6, s[44:47], s28 offen
    s_add_u32 s28, s28, 122880
    buffer_load_dwordx4 v[112:115], v6, s[44:47], s28 offen
    s_add_u32 s28, s28, 122880
    s_barrier
    buffer_load_dwordx4 v[16:19], v3, s[8:11], s32 offen offset:0
    buffer_load_dwordx4 v[20:23], v3, s[8:11], s29 offen offset:0
    buffer_load_dwordx4 v[24:27], v3, s[8:11], s32 offen offset:128
    buffer_load_dwordx4 v[28:31], v3, s[8:11], s29 offen offset:128
    buffer_load_dwordx4 v[32:35], v3, s[8:11], s32 offen offset:256
    buffer_load_dwordx4 v[36:39], v3, s[8:11], s29 offen offset:256
    buffer_load_dwordx4 v[40:43], v3, s[8:11], s32 offen offset:384
    buffer_load_dwordx4 v[44:47], v3, s[8:11], s29 offen offset:384
    buffer_load_dwordx4 v[48:51], v3, s[8:11], s32 offen offset:512
    buffer_load_dwordx4 v[52:55], v3, s[8:11], s29 offen offset:512
    buffer_load_dwordx4 v[56:59], v3, s[8:11], s32 offen offset:640
    buffer_load_dwordx4 v[60:63], v3, s[8:11], s29 offen offset:640
    buffer_load_dwordx4 v[64:67], v3, s[8:11], s32 offen offset:768
    buffer_load_dwordx4 v[68:71], v3, s[8:11], s29 offen offset:768
    buffer_load_dwordx4 v[72:75], v3, s[8:11], s32 offen offset:896
    buffer_load_dwordx4 v[76:79], v3, s[8:11], s29 offen offset:896
    buffer_load_dwordx4 v[80:83], v3, s[8:11], s32 offen offset:1024
    buffer_load_dwordx4 v[84:87], v3, s[8:11], s29 offen offset:1024
    buffer_load_dwordx4 v[88:91], v3, s[8:11], s32 offen offset:1152
    buffer_load_dwordx4 v[92:95], v3, s[8:11], s29 offen offset:1152
    s_waitcnt vmcnt(19)
    v_dot2_f32_bf16 v8, v16, s38, v8
    v_dot2_f32_bf16 v10, v16, v16, v10
    v_dot2_f32_bf16 v8, v17, s38, v8
    v_dot2_f32_bf16 v10, v17, v17, v10
    v_dot2_f32_bf16 v8, v18, s38, v8
    v_dot2_f32_bf16 v10, v18, v18, v10
    v_dot2_f32_bf16 v8, v19, s38, v8
    v_dot2_f32_bf16 v10, v19, v19, v10
    s_waitcnt vmcnt(18)
    v_dot2_f32_bf16 v9, v20, s38, v9
    v_dot2_f32_bf16 v11, v20, v20, v11
    v_dot2_f32_bf16 v9, v21, s38, v9
    v_dot2_f32_bf16 v11, v21, v21, v11
    v_dot2_f32_bf16 v9, v22, s38, v9
    v_dot2_f32_bf16 v11, v22, v22, v11
    v_dot2_f32_bf16 v9, v23, s38, v9
    v_dot2_f32_bf16 v11, v23, v23, v11
    s_waitcnt vmcnt(17)
    v_dot2_f32_bf16 v8, v24, s38, v8
    v_dot2_f32_bf16 v10, v24, v24, v10
    v_dot2_f32_bf16 v8, v25, s38, v8
    v_dot2_f32_bf16 v10, v25, v25, v10
    v_dot2_f32_bf16 v8, v26, s38, v8
    v_dot2_f32_bf16 v10, v26, v26, v10
    v_dot2_f32_bf16 v8, v27, s38, v8
    v_dot2_f32_bf16 v10, v27, v27, v10
    s_waitcnt vmcnt(16)
    v_dot2_f32_bf16 v9, v28, s38, v9
    v_dot2_f32_bf16 v11, v28, v28, v11
    v_dot2_f32_bf16 v9, v29, s38, v9
    v_dot2_f32_bf16 v11, v29, v29, v11
    v_dot2_f32_bf16 v9, v30, s38, v9
    v_dot2_f32_bf16 v11, v30, v30, v11
    v_dot2_f32_bf16 v9, v31, s38, v9
    v_dot2_f32_bf16 v11, v31, v31, v11
    s_waitcnt vmcnt(15)
    v_dot2_f32_bf16 v8, v32, s38, v8
    v_dot2_f32_bf16 v10, v32, v32, v10
    v_dot2_f32_bf16 v8, v33, s38, v8
    v_dot2_f32_bf16 v10, v33, v33, v10
    v_dot2_f32_bf16 v8, v34, s38, v8
    v_dot2_f32_bf16 v10, v34, v34, v10
    v_dot2_f32_bf16 v8, v35, s38, v8
    v_dot2_f32_bf16 v10, v35, v35, v10
    s_waitcnt vmcnt(14)
    v_dot2_f32_bf16 v9, v36, s38, v9
    v_dot2_f32_bf16 v11, v36, v36, v11
    v_dot2_f32_bf16 v9, v37, s38, v9
    v_dot2_f32_bf16 v11, v37, v37, v11
    v_dot2_f32_bf16 v9, v38, s38, v9
    v_dot2_f32_bf16 v11, v38, v38, v11
    v_dot2_f32_bf16 v9, v39, s38, v9
    v_dot2_f32_bf16 v11, v39, v39, v11
    s_waitcnt vmcnt(13)
    v_dot2_f32_bf16 v8, v40, s38, v8
    v_dot2_f32_bf16 v10, v40, v40, v10
    v_dot2_f32_bf16 v8, v41, s38, v8
    v_dot2_f32_bf16 v10, v41, v41, v10
    v_dot2_f32_bf16 v8, v42, s38, v8
    v_dot2_f32_bf16 v10, v42, v42, v10
    v_dot2_f32_bf16 v8, v43, s38, v8
    v_dot2_f32_bf16 v10, v43, v43, v10
    s_waitcnt vmcnt(12)
    v_dot2_f32_bf16 v9, v44, s38, v9
    v_dot2_f32_bf16 v11, v44, v44, v11
    v_dot2_f32_bf16 v9, v45, s38, v9
    v_dot2_f32_bf16 v11, v45, v45, v11
    v_dot2_f32_bf16 v9, v46, s38, v9
    v_dot2_f32_bf16 v11, v46, v46, v11
    v_dot2_f32_bf16 v9, v47, s38, v9
    v_dot2_f32_bf16 v11, v47, v47, v11
    s_waitcnt vmcnt(11)
    v_dot2_f32_bf16 v8, v48, s38, v8
    v_dot2_f32_bf16 v10, v48, v48, v10
    v_dot2_f32_bf16 v8, v49, s38, v8
    v_dot2_f32_bf16 v10, v49, v49, v10
    v_dot2_f32_bf16 v8, v50, s38, v8
    v_dot2_f32_bf16 v10, v50, v50, v10
    v_dot2_f32_bf16 v8, v51, s38, v8
    v_dot2_f32_bf16 v10, v51, v51, v10
    s_waitcnt vmcnt(10)
    v_dot2_f32_bf16 v9, v52, s38, v9
    v_dot2_f32_bf16 v11, v52, v52, v11
    v_dot2_f32_bf16 v9, v53, s38, v9
    v_dot2_f32_bf16 v11, v53, v53, v11
    v_dot2_f32_bf16 v9, v54, s38, v9
    v_dot2_f32_bf16 v11, v54, v54, v11
    v_dot2_f32_bf16 v9, v55, s38, v9
    v_dot2_f32_bf16 v11, v55, v55, v11
    s_waitcnt vmcnt(9)
    v_dot2_f32_bf16 v8, v56, s38, v8
    v_dot2_f32_bf16 v10, v56, v56, v10
    v_dot2_f32_bf16 v8, v57, s38, v8
    v_dot2_f32_bf16 v10, v57, v57, v10
    v_dot2_f32_bf16 v8, v58, s38, v8
    v_dot2_f32_bf16 v10, v58, v58, v10
    v_dot2_f32_bf16 v8, v59, s38, v8
    v_dot2_f32_bf16 v10, v59, v59, v10
    s_waitcnt vmcnt(8)
    v_dot2_f32_bf16 v9, v60, s38, v9
    v_dot2_f32_bf16 v11, v60, v60, v11
    v_dot2_f32_bf16 v9, v61, s38, v9
    v_dot2_f32_bf16 v11, v61, v61, v11
    v_dot2_f32_bf16 v9, v62, s38, v9
    v_dot2_f32_bf16 v11, v62, v62, v11
    v_dot2_f32_bf16 v9, v63, s38, v9
    v_dot2_f32_bf16 v11, v63, v63, v11
    s_waitcnt vmcnt(7)
    v_dot2_f32_bf16 v8, v64, s38, v8
    v_dot2_f32_bf16 v10, v64, v64, v10
    v_dot2_f32_bf16 v8, v65, s38, v8
    v_dot2_f32_bf16 v10, v65, v65, v10
    v_dot2_f32_bf16 v8, v66, s38, v8
    v_dot2_f32_bf16 v10, v66, v66, v10
    v_dot2_f32_bf16 v8, v67, s38, v8
    v_dot2_f32_bf16 v10, v67, v67, v10
    s_waitcnt vmcnt(6)
    v_dot2_f32_bf16 v9, v68, s38, v9
    v_dot2_f32_bf16 v11, v68, v68, v11
    v_dot2_f32_bf16 v9, v69, s38, v9
    v_dot2_f32_bf16 v11, v69, v69, v11
    v_dot2_f32_bf16 v9, v70, s38, v9
    v_dot2_f32_bf16 v11, v70, v70, v11
    v_dot2_f32_bf16 v9, v71, s38, v9
    v_dot2_f32_bf16 v11, v71, v71, v11
    s_waitcnt vmcnt(5)
    v_dot2_f32_bf16 v8, v72, s38, v8
    v_dot2_f32_bf16 v10, v72, v72, v10
    v_dot2_f32_bf16 v8, v73, s38, v8
    v_dot2_f32_bf16 v10, v73, v73, v10
    v_dot2_f32_bf16 v8, v74, s38, v8
    v_dot2_f32_bf16 v10, v74, v74, v10
    v_dot2_f32_bf16 v8, v75, s38, v8
    v_dot2_f32_bf16 v10, v75, v75, v10
    s_waitcnt vmcnt(4)
    v_dot2_f32_bf16 v9, v76, s38, v9
    v_dot2_f32_bf16 v11, v76, v76, v11
    v_dot2_f32_bf16 v9, v77, s38, v9
    v_dot2_f32_bf16 v11, v77, v77, v11
    v_dot2_f32_bf16 v9, v78, s38, v9
    v_dot2_f32_bf16 v11, v78, v78, v11
    v_dot2_f32_bf16 v9, v79, s38, v9
    v_dot2_f32_bf16 v11, v79, v79, v11
    s_waitcnt vmcnt(3)
    v_dot2_f32_bf16 v8, v80, s38, v8
    v_dot2_f32_bf16 v10, v80, v80, v10
    v_dot2_f32_bf16 v8, v81, s38, v8
    v_dot2_f32_bf16 v10, v81, v81, v10
    v_dot2_f32_bf16 v8, v82, s38, v8
    v_dot2_f32_bf16 v10, v82, v82, v10
    v_dot2_f32_bf16 v8, v83, s38, v8
    v_dot2_f32_bf16 v10, v83, v83, v10
    s_waitcnt vmcnt(2)
    v_dot2_f32_bf16 v9, v84, s38, v9
    v_dot2_f32_bf16 v11, v84, v84, v11
    v_dot2_f32_bf16 v9, v85, s38, v9
    v_dot2_f32_bf16 v11, v85, v85, v11
    v_dot2_f32_bf16 v9, v86, s38, v9
    v_dot2_f32_bf16 v11, v86, v86, v11
    v_dot2_f32_bf16 v9, v87, s38, v9
    v_dot2_f32_bf16 v11, v87, v87, v11
    s_waitcnt vmcnt(1)
    v_dot2_f32_bf16 v8, v88, s38, v8
    v_dot2_f32_bf16 v10, v88, v88, v10
    v_dot2_f32_bf16 v8, v89, s38, v8
    v_dot2_f32_bf16 v10, v89, v89, v10
    v_dot2_f32_bf16 v8, v90, s38, v8
    v_dot2_f32_bf16 v10, v90, v90, v10
    v_dot2_f32_bf16 v8, v91, s38, v8
    v_dot2_f32_bf16 v10, v91, v91, v10
    s_waitcnt vmcnt(0)
    v_dot2_f32_bf16 v9, v92, s38, v9
    v_dot2_f32_bf16 v11, v92, v92, v11
    v_dot2_f32_bf16 v9, v93, s38, v9
    v_dot2_f32_bf16 v11, v93, v93, v11
    v_dot2_f32_bf16 v9, v94, s38, v9
    v_dot2_f32_bf16 v11, v94, v94, v11
    v_dot2_f32_bf16 v9, v95, s38, v9
    v_dot2_f32_bf16 v11, v95, v95, v11
    v_add_f32_dpp v8, v8, v8 quad_perm:[1,0,3,2] row_mask:0xf bank_mask:0xf
    s_nop 0
    v_add_f32_dpp v9, v9, v9 quad_perm:[1,0,3,2] row_mask:0xf bank_mask:0xf
    v_add_f32_dpp v10, v10, v10 quad_perm:[1,0,3,2] row_mask:0xf bank_mask:0xf
    v_add_f32_dpp v11, v11, v11 quad_perm:[1,0,3,2] row_mask:0xf bank_mask:0xf
    v_add_f32_dpp v8, v8, v8 quad_perm:[2,3,0,1] row_mask:0xf bank_mask:0xf
    v_add_f32_dpp v9, v9, v9 quad_perm:[2,3,0,1] row_mask:0xf bank_mask:0xf
    v_add_f32_dpp v10, v10, v10 quad_perm:[2,3,0,1] row_mask:0xf bank_mask:0xf
    v_add_f32_dpp v11, v11, v11 quad_perm:[2,3,0,1] row_mask:0xf bank_mask:0xf
    v_add_f32_dpp v8, v8, v8 row_half_mirror row_mask:0xf bank_mask:0xf
    v_add_f32_dpp v9, v9, v9 row_half_mirror row_mask:0xf bank_mask:0xf
    v_add_f32_dpp v10, v10, v10 row_half_mirror row_mask:0xf bank_mask:0xf
    v_add_f32_dpp v11, v11, v11 row_half_mirror row_mask:0xf bank_mask:0xf
    s_mov_b32 s40, 0xaaaaaaaa
    s_mov_b32 s41, 0xaaaaaaaa
    v_cndmask_b32 v8, v8, v9, s[40:41]
    v_cndmask_b32 v10, v10, v11, s[40:41]
    v_mul_f32 v8, 0xbacccccd, v8
    v_mul_f32 v10, 0x3acccccd, v10
    v_fma_f32 v10, -v8, v8, v10
    v_max_f32 v10, 0, v10
    v_add_f32 v10, 0x3727c5ac, v10
    v_rsq_f32 v9, v10
    v_and_b32 v3, 1, v1
    v_lshl_add_u32 v3, v3, 3, v2
    v_lshlrev_b32 v3, 3, v3
    v_or_b32 v9, 1, v9
    s_mov_b32 exec_lo, 0x03030303
    s_mov_b32 exec_hi, 0x03030303
    buffer_store_dwordx2 v[8:9], v3, s[16:19], s30 offen sc1
    s_mov_b64 exec, -1
    s_barrier
    buffer_load_dwordx4 v[116:119], v6, s[44:47], s28 offen
    s_add_u32 s28, s28, 122880
    buffer_load_dwordx4 v[120:123], v6, s[44:47], s28 offen
    s_add_u32 s28, s28, 122880
    buffer_load_dwordx4 v[124:127], v6, s[44:47], s28 offen
    s_add_u32 s28, s28, 122880
    buffer_load_dwordx4 v[128:131], v6, s[44:47], s28 offen
    s_add_u32 s28, s28, 122880
    buffer_load_dwordx4 v[132:135], v6, s[44:47], s28 offen
    s_add_u32 s28, s28, 122880
    buffer_load_dwordx4 v[136:139], v6, s[44:47], s28 offen
    s_add_u32 s28, s28, 122880
    buffer_load_dwordx4 v[140:143], v6, s[44:47], s28 offen
    s_add_u32 s28, s28, 122880
    buffer_load_dwordx4 v[144:147], v6, s[44:47], s28 offen
    s_add_u32 s28, s28, 122880
    buffer_load_dwordx4 v[148:151], v6, s[44:47], s28 offen
    s_add_u32 s28, s28, 122880
    buffer_load_dwordx4 v[152:155], v6, s[44:47], s28 offen
    s_add_u32 s28, s28, 122880
    buffer_load_dwordx4 v[156:159], v6, s[44:47], s28 offen
    s_add_u32 s28, s28, 122880
    v_and_b32 v2, 15, v1
    v_lshlrev_b32 v2, 2, v2
    buffer_load_dword v3, v2, s[64:67], 0 offen sc1
    s_mul_i32 s32, s23, 192
    v_lshlrev_b32 v5, 1, v0
    buffer_load_ushort v15, v5, s[56:59], s32 offen
    s_mov_b32 s32, 0x00003f80
    s_mov_b32 s33, 0x3f800000
    v_mov_b32 v16, 0
    v_mov_b32 v17, 0
    v_mov_b32 v18, 0
    v_mov_b32 v19, 0
    v_mov_b32 v20, 0
    v_mov_b32 v21, 0
    v_mov_b32 v22, 0
    v_mov_b32 v23, 0
    v_dot2_f32_bf16 v16, v96, s32, v16
    v_dot2_f32_bf16 v17, v96, s33, v17
    v_dot2_f32_bf16 v18, v97, s32, v18
    v_dot2_f32_bf16 v19, v97, s33, v19
    v_dot2_f32_bf16 v20, v98, s32, v20
    v_dot2_f32_bf16 v21, v98, s33, v21
    v_dot2_f32_bf16 v22, v99, s32, v22
    v_dot2_f32_bf16 v23, v99, s33, v23
    v_dot2_f32_bf16 v16, v100, s32, v16
    v_dot2_f32_bf16 v17, v100, s33, v17
    v_dot2_f32_bf16 v18, v101, s32, v18
    v_dot2_f32_bf16 v19, v101, s33, v19
    v_dot2_f32_bf16 v20, v102, s32, v20
    v_dot2_f32_bf16 v21, v102, s33, v21
    v_dot2_f32_bf16 v22, v103, s32, v22
    v_dot2_f32_bf16 v23, v103, s33, v23
    v_dot2_f32_bf16 v16, v104, s32, v16
    v_dot2_f32_bf16 v17, v104, s33, v17
    v_dot2_f32_bf16 v18, v105, s32, v18
    v_dot2_f32_bf16 v19, v105, s33, v19
    v_dot2_f32_bf16 v20, v106, s32, v20
    v_dot2_f32_bf16 v21, v106, s33, v21
    v_dot2_f32_bf16 v22, v107, s32, v22
    v_dot2_f32_bf16 v23, v107, s33, v23
    v_dot2_f32_bf16 v16, v108, s32, v16
    v_dot2_f32_bf16 v17, v108, s33, v17
    v_dot2_f32_bf16 v18, v109, s32, v18
    v_dot2_f32_bf16 v19, v109, s33, v19
    v_dot2_f32_bf16 v20, v110, s32, v20
    v_dot2_f32_bf16 v21, v110, s33, v21
    v_dot2_f32_bf16 v22, v111, s32, v22
    v_dot2_f32_bf16 v23, v111, s33, v23
    v_dot2_f32_bf16 v16, v112, s32, v16
    v_dot2_f32_bf16 v17, v112, s33, v17
    v_dot2_f32_bf16 v18, v113, s32, v18
    v_dot2_f32_bf16 v19, v113, s33, v19
    v_dot2_f32_bf16 v20, v114, s32, v20
    v_dot2_f32_bf16 v21, v114, s33, v21
    v_dot2_f32_bf16 v22, v115, s32, v22
    v_dot2_f32_bf16 v23, v115, s33, v23
    s_waitcnt vmcnt(12)
    v_dot2_f32_bf16 v16, v116, s32, v16
    v_dot2_f32_bf16 v17, v116, s33, v17
    v_dot2_f32_bf16 v18, v117, s32, v18
    v_dot2_f32_bf16 v19, v117, s33, v19
    v_dot2_f32_bf16 v20, v118, s32, v20
    v_dot2_f32_bf16 v21, v118, s33, v21
    v_dot2_f32_bf16 v22, v119, s32, v22
    v_dot2_f32_bf16 v23, v119, s33, v23
    s_waitcnt vmcnt(11)
    v_dot2_f32_bf16 v16, v120, s32, v16
    v_dot2_f32_bf16 v17, v120, s33, v17
    v_dot2_f32_bf16 v18, v121, s32, v18
    v_dot2_f32_bf16 v19, v121, s33, v19
    v_dot2_f32_bf16 v20, v122, s32, v20
    v_dot2_f32_bf16 v21, v122, s33, v21
    v_dot2_f32_bf16 v22, v123, s32, v22
    v_dot2_f32_bf16 v23, v123, s33, v23
    s_waitcnt vmcnt(10)
    v_dot2_f32_bf16 v16, v124, s32, v16
    v_dot2_f32_bf16 v17, v124, s33, v17
    v_dot2_f32_bf16 v18, v125, s32, v18
    v_dot2_f32_bf16 v19, v125, s33, v19
    v_dot2_f32_bf16 v20, v126, s32, v20
    v_dot2_f32_bf16 v21, v126, s33, v21
    v_dot2_f32_bf16 v22, v127, s32, v22
    v_dot2_f32_bf16 v23, v127, s33, v23
    s_waitcnt vmcnt(9)
    v_dot2_f32_bf16 v16, v128, s32, v16
    v_dot2_f32_bf16 v17, v128, s33, v17
    v_dot2_f32_bf16 v18, v129, s32, v18
    v_dot2_f32_bf16 v19, v129, s33, v19
    v_dot2_f32_bf16 v20, v130, s32, v20
    v_dot2_f32_bf16 v21, v130, s33, v21
    v_dot2_f32_bf16 v22, v131, s32, v22
    v_dot2_f32_bf16 v23, v131, s33, v23
    s_waitcnt vmcnt(8)
    v_dot2_f32_bf16 v16, v132, s32, v16
    v_dot2_f32_bf16 v17, v132, s33, v17
    v_dot2_f32_bf16 v18, v133, s32, v18
    v_dot2_f32_bf16 v19, v133, s33, v19
    v_dot2_f32_bf16 v20, v134, s32, v20
    v_dot2_f32_bf16 v21, v134, s33, v21
    v_dot2_f32_bf16 v22, v135, s32, v22
    v_dot2_f32_bf16 v23, v135, s33, v23
    s_waitcnt vmcnt(7)
    v_dot2_f32_bf16 v16, v136, s32, v16
    v_dot2_f32_bf16 v17, v136, s33, v17
    v_dot2_f32_bf16 v18, v137, s32, v18
    v_dot2_f32_bf16 v19, v137, s33, v19
    v_dot2_f32_bf16 v20, v138, s32, v20
    v_dot2_f32_bf16 v21, v138, s33, v21
    v_dot2_f32_bf16 v22, v139, s32, v22
    v_dot2_f32_bf16 v23, v139, s33, v23
    s_waitcnt vmcnt(6)
    v_dot2_f32_bf16 v16, v140, s32, v16
    v_dot2_f32_bf16 v17, v140, s33, v17
    v_dot2_f32_bf16 v18, v141, s32, v18
    v_dot2_f32_bf16 v19, v141, s33, v19
    v_dot2_f32_bf16 v20, v142, s32, v20
    v_dot2_f32_bf16 v21, v142, s33, v21
    v_dot2_f32_bf16 v22, v143, s32, v22
    v_dot2_f32_bf16 v23, v143, s33, v23
    s_waitcnt vmcnt(5)
    v_dot2_f32_bf16 v16, v144, s32, v16
    v_dot2_f32_bf16 v17, v144, s33, v17
    v_dot2_f32_bf16 v18, v145, s32, v18
    v_dot2_f32_bf16 v19, v145, s33, v19
    v_dot2_f32_bf16 v20, v146, s32, v20
    v_dot2_f32_bf16 v21, v146, s33, v21
    v_dot2_f32_bf16 v22, v147, s32, v22
    v_dot2_f32_bf16 v23, v147, s33, v23
    s_waitcnt vmcnt(4)
    v_dot2_f32_bf16 v16, v148, s32, v16
    v_dot2_f32_bf16 v17, v148, s33, v17
    v_dot2_f32_bf16 v18, v149, s32, v18
    v_dot2_f32_bf16 v19, v149, s33, v19
    v_dot2_f32_bf16 v20, v150, s32, v20
    v_dot2_f32_bf16 v21, v150, s33, v21
    v_dot2_f32_bf16 v22, v151, s32, v22
    v_dot2_f32_bf16 v23, v151, s33, v23
    s_waitcnt vmcnt(3)
    v_dot2_f32_bf16 v16, v152, s32, v16
    v_dot2_f32_bf16 v17, v152, s33, v17
    v_dot2_f32_bf16 v18, v153, s32, v18
    v_dot2_f32_bf16 v19, v153, s33, v19
    v_dot2_f32_bf16 v20, v154, s32, v20
    v_dot2_f32_bf16 v21, v154, s33, v21
    v_dot2_f32_bf16 v22, v155, s32, v22
    v_dot2_f32_bf16 v23, v155, s33, v23
    s_waitcnt vmcnt(2)
    v_dot2_f32_bf16 v16, v156, s32, v16
    v_dot2_f32_bf16 v17, v156, s33, v17
    v_dot2_f32_bf16 v18, v157, s32, v18
    v_dot2_f32_bf16 v19, v157, s33, v19
    v_dot2_f32_bf16 v20, v158, s32, v20
    v_dot2_f32_bf16 v21, v158, s33, v21
    v_dot2_f32_bf16 v22, v159, s32, v22
    v_dot2_f32_bf16 v23, v159, s33, v23
    s_mov_b32 s35, 0x10000
    s_waitcnt vmcnt(0)
A_polla:
    v_cmp_eq_u32 vcc, 0, v3
    s_cbranch_vccz A_pollxa
    buffer_load_dword v3, v2, s[64:67], 0 offen sc1
    s_waitcnt vmcnt(0)
    s_sub_u32 s35, s35, 1
    s_cbranch_scc0 A_polla
A_pollxa:
    v_lshlrev_b32 v4, 5, v0
    ds_write_b128 v4, v[16:19]
    ds_write_b128 v4, v[20:23] offset:16
    s_waitcnt lgkmcnt(0)
    s_barrier
    v_lshlrev_b32 v4, 2, v0
    ds_read_b32 v16, v4 offset:0
    ds_read_b32 v17, v4 offset:1536
    ds_read_b32 v18, v4 offset:3072
    ds_read_b32 v19, v4 offset:4608
    ds_read_b32 v20, v4 offset:6144
    ds_read_b32 v21, v4 offset:7680
    ds_read_b32 v22, v4 offset:9216
    ds_read_b32 v23, v4 offset:10752
    ds_read_b32 v24, v4 offset:12288
    ds_read_b32 v25, v4 offset:13824
    s_waitcnt lgkmcnt(0)
    v_add_f32 v16, v16, v21
    v_add_f32 v17, v17, v22
    v_add_f32 v18, v18, v23
    v_add_f32 v19, v19, v24
    v_add_f32 v20, v20, v25
    v_add_f32 v16, v16, v17
    v_add_f32 v16, v16, v18
    v_add_f32 v16, v16, v19
    v_add_f32 v16, v16, v20
    ds_write_b32 v4, v16 offset:20480
    s_waitcnt lgkmcnt(0)
    s_barrier
    s_cmp_ge_u32 s20, 2
    s_cbranch_scc1 A_aux3
    ds_read_b32 v16, v4 offset:20480
    ds_read_b32 v17, v4 offset:20864
    ds_read_b32 v18, v4 offset:21248
    ds_read_b32 v19, v4 offset:21632
    s_waitcnt lgkmcnt(0)
    v_add_f32 v16, v16, v17
    v_add_f32 v16, v16, v18
    v_add_f32 v16, v16, v19
    v_cvt_pk_bf16_f32 v8, v16, v16
    v_and_b32 v2, 0xffff0000, v8
    v_sub_f32 v2, v16, v2
    v_cvt_pk_bf16_f32 v9, v2, 0
    s_waitcnt vmcnt(0)
    v_lshl_or_b32 v9, v15, 16, v9
    v_mov_b32 v10, v15
    v_mov_b32 v11, 0
    v_lshlrev_b32 v4, 4, v0
    s_mul_i32 s32, s23, 1536
    s_add_u32 s32, s32, 19398656
    v_cmp_gt_u32 vcc, 96, v0
    s_nop 0
    s_mov_b64 exec, vcc
    buffer_store_dwordx4 v[8:11], v4, s[16:19], s32 offen sc1
    s_mov_b64 exec, -1
A_aux3:
    s_branch A_nofl
F_entry:
    s_mov_b32 s42, s3
    s_mov_b32 s69, s71
    s_load_dwordx2 s[8:9], s[0:1], 80
    v_lshrrev_b32 v2, 6, v0
    v_and_b32 v1, 63, v0
    v_readfirstlane_b32 s12, v2
    s_and_b32 s66, s2, 7
    s_lshr_b32 s67, s2, 3
    v_lshrrev_b32 v6, 5, v1
    v_lshlrev_b32 v7, 4, v1
    s_and_b32 s13, s12, 3
    s_lshr_b32 s14, s12, 2
    v_and_b32 v2, 0x1f0, v7
    v_lshl_add_u32 v12, v6, 15, v2
    v_add_u32 v13, 65536, v2
    s_mul_i32 s21, s67, 81920
    s_lshl2_add_u32 s17, s66, s13
    s_lshl_b32 s17, s17, 9
    s_add_u32 s17, s17, s21
    s_add_u32 s19, s17, 16384
    s_add_u32 s21, s21, 2621440
    s_add_u32 s25, s21, 3072
    v_mul_u32_u24 v3, 10240, v6
    v_add_u32 v8, v2, v3
    s_mov_b32 s34, 0xfffff
    s_mov_b32 s35, 0xfffff
    s_lshl_b32 s18, s13, 4
    s_lshl_b64 s[36:37], 0xffff, s18
    s_lshl_b32 s30, s13, 10
    s_lshl_b32 s27, s14, 13
    s_add_u32 s27, s27, s21
    s_lshl_b32 s26, s13, 14
    s_add_u32 s26, s26, s27
    s_lshl_b32 s28, s14, 5
    s_add_u32 s28, s28, s13
    s_mul_i32 s28, s28, 40960
    s_mul_i32 s18, s67, 320
    s_add_u32 s28, s28, s18
    s_mul_i32 s32, s14, 79872
    s_add_u32 s29, s32, s30
    s_add_u32 s31, s29, s30
    s_mov_b32 s10, 0x2000000
    s_mov_b32 s11, 0x20000
    s_mov_b32 s62, s17
    s_mov_b32 s63, s19
    s_mov_b32 s40, -1
    s_mov_b32 s41, 0
    v_and_b32 v2, 0x1f0, v7
    v_lshl_add_u32 v9, v6, 11, v2
    v_add_u32 v9, s32, v9
    v_add_u32 v3, 0x1000, v2
    v_mov_b32 v4, 5440
    v_cndmask_b32 v10, v4, v3, s[40:41]
    v_add_u32 v10, s32, v10
    s_add_u32 s17, s32, 5120
    v_add_u32 v11, s17, v7
    s_mov_b32 exec_lo, 0xffe00000
    s_mov_b32 exec_hi, 0xffe00000
    v_mov_b32 v11, 0x80000
    s_mov_b64 exec, -1
    s_mov_b32 s23, 0
    s_mov_b32 s15, 0x07060302
    s_mov_b32 s24, 1
    s_mul_i32 s17, s13, 640
    s_mul_i32 s18, s67, 20
    s_add_u32 s17, s17, s18
    v_bfe_u32 v3, v1, 4, 1
    v_mul_u32_u24 v3, 19, v3
    v_add_u32 v3, s17, v3
    v_lshrrev_b32 v3, 7, v3
    v_and_b32 v4, 15, v1
    v_lshlrev_b32 v4, 7, v4
    v_lshl_add_u32 v192, v3, 11, v4
    s_and_b32 s56, s67, 3
    s_lshl2_add_u32 s56, s66, s56
    s_lshr_b32 s57, s67, 2
    s_waitcnt lgkmcnt(0)
    s_mov_b64 s[4:5], s[8:9]
    s_mov_b32 s6, 0x0
    s_mov_b32 s7, 0x20000
    s_cmp_eq_u32 s14, 0
    s_cselect_b64 s[38:39], 0, -1
    s_cbranch_scc1 F_psetup
    v_mov_b32 v152, 0
    v_mov_b32 v153, 0
    v_mov_b32 v154, 0
    v_mov_b32 v156, 0
    v_mov_b32 v157, 0
    v_mov_b32 v158, 0
    s_waitcnt vmcnt(0)
    s_barrier
    v_bfe_u32 v3, v1, 2, 2
    v_and_b32 v4, 3, v1
    v_bfe_u32 v5, v1, 4, 1
    s_cmp_eq_u32 s69, 48
    s_cbranch_scc1 F_rt1
    v_lshl_add_u32 v3, v5, 2, v3
    v_lshl_add_u32 v3, v6, 4, v3
    v_mul_u32_u24 v3, 640, v3
    v_lshl_add_u32 v3, v4, 3, v3
    s_mul_i32 s17, s13, 160
    v_add_u32 v3, s17, v3
    ds_read_b64_tr_b16 v[160:161], v3 offset:4096
    ds_read_b64_tr_b16 v[162:163], v3 offset:9216
    ds_read_b64_tr_b16 v[164:165], v3 offset:4128
    ds_read_b64_tr_b16 v[166:167], v3 offset:9248
    ds_read_b64_tr_b16 v[168:169], v3 offset:4160
    ds_read_b64_tr_b16 v[170:171], v3 offset:9280
    ds_read_b64_tr_b16 v[172:173], v3 offset:4192
    ds_read_b64_tr_b16 v[174:175], v3 offset:9312
    ds_read_b64_tr_b16 v[176:177], v3 offset:4224
    ds_read_b64_tr_b16 v[178:179], v3 offset:9344
    s_branch F_rt2
F_rt1:
    v_lshl_add_u32 v3, v6, 2, v3
    v_mul_u32_u24 v3, 768, v3
    v_lshl_add_u32 v3, v4, 3, v3
    v_lshl_add_u32 v3, v5, 5, v3
    s_mul_i32 s17, s13, 192
    v_add_u32 v3, s17, v3
    ds_read_b64_tr_b16 v[160:161], v3 offset:4096
    ds_read_b64_tr_b16 v[162:163], v3 offset:10240
    ds_read_b64_tr_b16 v[164:165], v3 offset:4160
    ds_read_b64_tr_b16 v[166:167], v3 offset:10304
    ds_read_b64_tr_b16 v[168:169], v3 offset:4224
    ds_read_b64_tr_b16 v[170:171], v3 offset:10368
    ds_read_b64_tr_b16 v[172:173], v3 offset:16384
    ds_read_b64_tr_b16 v[174:175], v3 offset:22528
    ds_read_b64_tr_b16 v[176:177], v3 offset:16448
    ds_read_b64_tr_b16 v[178:179], v3 offset:22592
    ds_read_b64_tr_b16 v[180:181], v3 offset:16512
    ds_read_b64_tr_b16 v[182:183], v3 offset:22656
F_rt2:
    s_waitcnt lgkmcnt(0)
    s_add_u32 s17, s42, 4096
    s_cmp_eq_u32 s69, 48
    s_cselect_b32 s18, s17, 0x40000000
    buffer_store_dwordx4 v[160:163], v7, s[8:11], s42 offen offset:0 sc1
    buffer_store_dwordx4 v[164:167], v7, s[8:11], s42 offen offset:1024 sc1
    buffer_store_dwordx4 v[168:171], v7, s[8:11], s42 offen offset:2048 sc1
    buffer_store_dwordx4 v[172:175], v7, s[8:11], s42 offen offset:3072 sc1
    buffer_store_dwordx4 v[176:179], v7, s[8:11], s17 offen offset:0 sc1
    buffer_store_dwordx4 v[180:183], v7, s[8:11], s18 offen offset:1024 sc1
    s_branch F_af
F_psetup:
    v_mov_b32 v3, 0
    v_mov_b32 v4, 1
    s_mov_b64 exec, 1
    s_waitcnt vmcnt(0)
    buffer_store_dword v4, v3, s[8:11], s70 offen sc1
    s_mov_b64 exec, -1
    s_barrier
    s_load_dwordx2 s[44:45], s[0:1], 0
    s_load_dwordx2 s[48:49], s[0:1], 64
    s_load_dwordx2 s[52:53], s[0:1], 56
    s_mov_b32 s46, 0x280000
    s_mov_b32 s47, 0x20000
    s_mov_b32 s50, 0x280000
    s_mov_b32 s51, 0x20000
    s_mov_b32 s54, 0x500
    s_mov_b32 s55, 0x20000
    v_mov_b32 v150, v7
    s_lshr_b32 s18, s13, 1
    s_mul_i32 s17, s18, 79872
    s_add_u32 s17, s17, 26624
    v_add_u32 v150, s17, v150
    s_mov_b32 s17, 0x1999999a
    v_add_u32 v2, 0, v1
    v_mul_hi_u32 v3, s17, v2
    v_mul_u32_u24 v3, 1120, v3
    v_lshl_add_u32 v152, v2, 4, v3
    v_add_u32 v2, 64, v1
    v_mul_hi_u32 v3, s17, v2
    v_mul_u32_u24 v3, 1120, v3
    v_lshl_add_u32 v153, v2, 4, v3
    v_add_u32 v2, 128, v1
    v_mul_hi_u32 v3, s17, v2
    v_mul_u32_u24 v3, 1120, v3
    v_lshl_add_u32 v154, v2, 4, v3
    v_and_b32 v2, 15, v1
    v_mul_u32_u24 v155, 160, v2
    v_lshrrev_b32 v3, 4, v1
    v_lshl_add_u32 v155, v3, 3, v155
    s_mul_i32 s18, s13, 2560
    v_add_u32 v155, s18, v155
    v_mul_u32_u24 v4, 1280, v2
    v_lshl_add_u32 v158, v3, 3, v4
    s_and_b32 s17, s13, 1
    s_lshl1_add_u32 s17, s56, s17
    s_lshr_b32 s18, s13, 1
    s_lshl1_add_u32 s17, s17, s18
    s_mul_i32 s17, s17, 20480
    s_mul_i32 s18, s57, 160
    s_add_u32 s70, s17, s18
    v_bfe_u32 v4, v1, 4, 1
    v_lshlrev_b32 v156, 9, v4
    v_lshl_add_u32 v156, v2, 4, v156
    v_lshl_add_u32 v157, v6, 10, v156
    v_lshl_add_u32 v156, v6, 3, v156
    s_waitcnt lgkmcnt(0)
    buffer_load_dwordx2 v[140:141], v158, s[44:47], s70 offen offset:0
    buffer_load_dwordx2 v[142:143], v158, s[44:47], s70 offen offset:32
    buffer_load_dwordx2 v[144:145], v158, s[44:47], s70 offen offset:64
    buffer_load_dwordx2 v[146:147], v158, s[44:47], s70 offen offset:96
    buffer_load_dwordx2 v[148:149], v158, s[44:47], s70 offen offset:128
    s_cmp_eq_u32 s13, 3
    s_cbranch_scc1 F_af
    s_mov_b32 s17, 19496960
    s_mov_b32 s19, 65536
    s_lshl_b32 s18, s66, 1
    s_lshl_b32 s18, 0x30003, s18
    s_cmp_eq_u32 s13, 0
    s_cselect_b32 exec_lo, s18, 0x88888888
    s_mov_b32 exec_hi, 0
F_polla:
    buffer_load_dwordx4 v[132:135], v192, s[8:11], s17 offen sc1
    s_waitcnt vmcnt(0)
    v_and_b32 v132, v132, v133
    v_and_b32 v134, v134, v135
    v_and_b32 v132, v132, v134
    v_cmp_ne_u32 vcc, 1, v132
    s_cbranch_vccz F_af
    s_sleep 1
    s_sub_u32 s19, s19, 1
    s_cbranch_scc0 F_polla
F_af:
    s_mov_b64 exec, -1
    s_barrier
    s_cmp_lg_u32 s14, 0
    buffer_load_dwordx4 v[84:87], v12, s[8:11], s62 offen
    buffer_load_dwordx4 v[88:91], v12, s[8:11], s63 offen
    buffer_load_dwordx4 v[92:95], v13, s[8:11], s62 offen
    s_cbranch_scc1 F_nok
    s_add_u32 s18, s25, 16384
    buffer_load_dwordx2 v[36:37], v12, s[8:11], s25 offen
    buffer_load_dwordx2 v[38:39], v12, s[8:11], s18 offen
    buffer_load_dwordx2 v[48:49], v13, s[8:11], s25 offen
F_nok:
    s_add_u32 m0, s29, 0
    s_add_u32 s18, s26, 3072
    buffer_load_dwordx4 v7, s[8:11], s18 offen sc1 lds
    s_add_u32 m0, s32, 4096
    s_add_u32 s18, s27, 68608
    s_mov_b64 exec, s[36:37]
    buffer_load_dwordx4 v7, s[8:11], s18 offen sc1 lds
    s_mov_b64 exec, -1
    s_add_u32 m0, s31, 5120
    s_add_u32 s18, s28, 5734400
    s_mov_b64 exec, s[34:35]
    buffer_load_dwordx4 v8, s[8:11], s18 offen sc1 lds
    s_add_u32 m0, m0, 1024
    s_add_u32 s18, s18, 20480
    buffer_load_dwordx4 v8, s[8:11], s18 offen sc1 lds
    s_mov_b64 exec, -1
    s_cmp_eq_u32 s14, 0
    s_cbranch_scc1 F_pdone
    v_mov_b32 v3, 0
    v_mov_b32 v4, 159744
    ds_write_b32 v4, v3
    v_subrev_u32 v3, 256, v0
    v_lshrrev_b32 v4, 4, v3
    v_mul_u32_u24 v4, 13312, v4
    v_and_b32 v3, 15, v0
    v_lshl_add_u32 v4, v3, 9, v4
    v_mov_b32 v132, 0x3f803f80
    v_mov_b32 v133, 0x3f803f80
    v_mov_b32 v134, 0x3f803f80
    v_mov_b32 v135, 0x3f803f80
    s_cmp_eq_u32 s12, 7
    s_cbranch_scc1 F_noonesa
    ds_write_b128 v4, v[132:135] offset:5440
F_noonesa:
F_pdone:
    s_waitcnt vmcnt(4)
    v_cndmask_b32 v16, v84, v86, s[38:39]
    v_cndmask_b32 v17, v85, v87, s[38:39]
    v_cndmask_b32 v18, v88, v90, s[38:39]
    v_cndmask_b32 v19, v89, v91, s[38:39]
    v_cndmask_b32 v24, v92, v94, s[38:39]
    v_cndmask_b32 v25, v93, v95, s[38:39]
    v_cndmask_b32 v20, v86, v84, s[38:39]
    v_cndmask_b32 v21, v87, v85, s[38:39]
    v_cndmask_b32 v22, v90, v88, s[38:39]
    v_cndmask_b32 v23, v91, v89, s[38:39]
    v_cndmask_b32 v26, v94, v92, s[38:39]
    v_cndmask_b32 v27, v95, v93, s[38:39]
F_maxpass:
    s_lshl_b32 s17, s13, 9
    s_add_u32 s17, s17, 160256
    v_lshl_add_u32 v132, v1, 3, s17
    s_cmp_lg_u32 s14, 0
    s_cbranch_scc1 F_maxskip
    v_cndmask_b32 v24, 0, v24, s[40:41]
    v_cndmask_b32 v25, 0, v25, s[40:41]
    v_mov_b32 v14, 0xff800000
    v_cndmask_b32 v26, 0, v26, s[40:41]
    v_cndmask_b32 v27, 0, v27, s[40:41]
    v_mov_b32 v15, 0xff800000
    s_mov_b32 s20, 0
F_maxloop:
    v_mfma_f32_32x32x16_bf16 v[68:83], v[36:39], v[16:19], 0
    v_mfma_f32_32x32x16_bf16 v[84:99], v[36:39], v[20:23], 0
    v_mfma_f32_32x32x8_bf16 v[68:83], v[48:49], v[24:25], v[68:83]
    v_mfma_f32_32x32x8_bf16 v[84:99], v[48:49], v[26:27], v[84:99]
    s_add_u32 s20, s20, 1
    s_nop 9
    v_max3_f32 v14, v68, v69, v14
    v_max3_f32 v15, v84, v85, v15
    v_max3_f32 v14, v70, v71, v14
    v_max3_f32 v15, v86, v87, v15
    v_max3_f32 v14, v72, v73, v14
    v_max3_f32 v15, v88, v89, v15
    v_max3_f32 v14, v74, v75, v14
    v_max3_f32 v15, v90, v91, v15
    v_max3_f32 v14, v76, v77, v14
    v_max3_f32 v15, v92, v93, v15
    v_max3_f32 v14, v78, v79, v14
    v_max3_f32 v15, v94, v95, v15
    v_max3_f32 v14, v80, v81, v14
    v_max3_f32 v15, v96, v97, v15
    v_max3_f32 v14, v82, v83, v14
    v_max3_f32 v15, v98, v99, v15
    s_cmp_ge_u32 s20, s24
    s_cbranch_scc1 F_maxdone
    s_bitcmp1_b32 s20, 0
    s_cselect_b32 s17, 8, 504
    s_add_u32 s25, s25, s17
    s_add_u32 s18, s25, 16384
    buffer_load_dwordx2 v[36:37], v12, s[8:11], s25 offen
    buffer_load_dwordx2 v[38:39], v12, s[8:11], s18 offen
    buffer_load_dwordx2 v[48:49], v13, s[8:11], s25 offen
    s_waitcnt vmcnt(0)
    s_branch F_maxloop
F_maxdone:
    v_permlane32_swap_b32 v14, v15
    v_max_f32 v2, v14, v15
    v_xor_b32 v2, 0x80000000, v2
    v_and_b32 v3, 0xffff0000, v2
    v_sub_f32 v4, v2, v3
    v_and_b32 v5, 0xffff0000, v4
    v_sub_f32 v4, v4, v5
    v_cvt_pk_bf16_f32 v134, v3, v5
    v_cvt_pk_bf16_f32 v135, v4, 0
    ds_write_b64 v132, v[134:135]
F_maxskip:
    s_lshl_b32 s17, s14, 8
    v_xor_b32 v133, s17, v132
    v_xor_b32 v132, 0x100, v133
    s_waitcnt vmcnt(2) lgkmcnt(0)
    s_barrier
    s_mov_b32 exec_lo, 0
    ds_read_b64 v[24:25], v132
    ds_read_b64 v[26:27], v133
    s_mov_b32 exec_lo, -1
    ds_read2_b64 v[28:31], v9 offset0:0 offset1:128
    ds_read2_b64 v[32:35], v9 offset0:1 offset1:129
    ds_read_b128 v[44:47], v10 offset:0
    s_add_u32 m0, s29, 13312
    s_add_u32 s18, s26, 7168
    buffer_load_dwordx4 v7, s[8:11], s18 offen sc1 lds
    s_add_u32 m0, s32, 17408
    s_add_u32 s18, s27, 72704
    s_mov_b64 exec, s[36:37]
    buffer_load_dwordx4 v7, s[8:11], s18 offen sc1 lds
    s_mov_b64 exec, -1
    s_add_u32 m0, s31, 18432
    s_add_u32 s18, s28, 6389760
    s_mov_b64 exec, s[34:35]
    buffer_load_dwordx4 v8, s[8:11], s18 offen sc1 lds
    s_add_u32 m0, m0, 1024
    s_add_u32 s18, s18, 20480
    buffer_load_dwordx4 v8, s[8:11], s18 offen sc1 lds
    s_mov_b64 exec, -1
    s_waitcnt lgkmcnt(0)
    v_mfma_f32_32x32x16_bf16 v[68:83], v[28:31], v[16:19], 0
    v_mfma_f32_32x32x8_bf16 v[68:83], v[44:45], v[24:25], v[68:83]
    s_waitcnt vmcnt(4)
    s_barrier
    ds_read_b128 v[52:55], v11 offset:0
    ds_read_b128 v[56:59], v11 offset:1024
    s_cmp_le_u32 s14, s23
    s_cbranch_scc1 F_rb
    s_lshl_b32 s17, s2, 7
    s_lshl2_add_u32 s17, s13, s17
    s_add_u32 s17, s17, 19529728
    v_mov_b32 v3, 0
    v_mov_b32 v4, 1
    s_mov_b64 exec, 1
    buffer_store_dword v4, v3, s[8:11], s17 offen sc1
    s_mov_b64 exec, -1
F_rb:
    v_mfma_f32_32x32x16_bf16 v[84:99], v[28:31], v[20:23], 0
    s_and_b32 s58, s67, 1
    s_lshl1_add_u32 s58, s66, s58
    s_nop 2
    v_exp_f32 v68, v68
    v_exp_f32 v69, v69
    v_exp_f32 v70, v70
    v_exp_f32 v71, v71
    v_cvt_pk_bf16_f32 v132, v68, v69
    v_cvt_pk_bf16_f32 v133, v70, v71
    v_mfma_f32_32x32x8_bf16 v[84:99], v[44:45], v[26:27], v[84:99]
    s_setprio 3
    s_lshr_b32 s59, s67, 1
    s_mul_i32 s3, s57, 245760
    v_exp_f32 v72, v72
    v_exp_f32 v73, v73
    v_exp_f32 v74, v74
    v_exp_f32 v75, v75
    v_cvt_pk_bf16_f32 v134, v72, v73
    v_cvt_pk_bf16_f32 v135, v74, v75
    s_waitcnt lgkmcnt(0)
    v_exp_f32 v76, v76
    v_exp_f32 v77, v77
    v_exp_f32 v78, v78
    v_exp_f32 v79, v79
    v_cvt_pk_bf16_f32 v136, v76, v77
    v_cvt_pk_bf16_f32 v137, v78, v79
    v_mfma_f32_32x32x16_bf16 v[100:115], v[52:55], v[132:135], 0
    ds_read_b128 v[60:63], v11 offset:2048
    v_exp_f32 v80, v80
    v_exp_f32 v81, v81
    v_exp_f32 v82, v82
    v_exp_f32 v83, v83
    v_cvt_pk_bf16_f32 v138, v80, v81
    v_cvt_pk_bf16_f32 v139, v82, v83
    v_mfma_f32_32x32x16_bf16 v[68:83], v[32:35], v[16:19], 0
    ds_read_b128 v[64:67], v11 offset:3072
    v_exp_f32 v84, v84
    v_exp_f32 v85, v85
    v_exp_f32 v86, v86
    v_exp_f32 v87, v87
    v_cvt_pk_bf16_f32 v132, v84, v85
    v_cvt_pk_bf16_f32 v133, v86, v87
    v_mfma_f32_32x32x8_bf16 v[68:83], v[46:47], v[24:25], v[68:83]
    s_setprio 2
    ds_read2_b64 v[36:39], v9 offset0:64 offset1:192
    v_exp_f32 v88, v88
    v_exp_f32 v89, v89
    v_exp_f32 v90, v90
    v_exp_f32 v91, v91
    v_cvt_pk_bf16_f32 v134, v88, v89
    v_cvt_pk_bf16_f32 v135, v90, v91
    v_mfma_f32_32x32x16_bf16 v[100:115], v[56:59], v[136:139], v[100:115]
    ds_read2_b64 v[40:43], v9 offset0:65 offset1:193
    v_exp_f32 v92, v92
    v_exp_f32 v93, v93
    v_exp_f32 v94, v94
    v_exp_f32 v95, v95
    v_cvt_pk_bf16_f32 v136, v92, v93
    v_cvt_pk_bf16_f32 v137, v94, v95
    v_mfma_f32_32x32x16_bf16 v[116:131], v[52:55], v[132:135], 0
    ds_read_b128 v[48:51], v10 offset:512
    v_exp_f32 v96, v96
    v_exp_f32 v97, v97
    v_exp_f32 v98, v98
    v_exp_f32 v99, v99
    v_cvt_pk_bf16_f32 v138, v96, v97
    v_cvt_pk_bf16_f32 v139, v98, v99
    v_mfma_f32_32x32x16_bf16 v[84:99], v[32:35], v[20:23], 0
    s_add_u32 s3, s3, s30
    s_mul_i32 s43, s59, 122880
    v_exp_f32 v68, v68
    v_exp_f32 v69, v69
    v_exp_f32 v70, v70
    v_exp_f32 v71, v71
    v_cvt_pk_bf16_f32 v132, v68, v69
    v_cvt_pk_bf16_f32 v133, v70, v71
    v_mfma_f32_32x32x8_bf16 v[84:99], v[46:47], v[26:27], v[84:99]
    s_setprio 1
    s_add_u32 s43, s43, s30
    s_add_u32 s43, s43, 20971520
    v_exp_f32 v72, v72
    v_exp_f32 v73, v73
    v_exp_f32 v74, v74
    v_exp_f32 v75, v75
    v_cvt_pk_bf16_f32 v134, v72, v73
    v_cvt_pk_bf16_f32 v135, v74, v75
    v_mfma_f32_32x32x16_bf16 v[116:131], v[56:59], v[136:139], v[116:131]
    s_waitcnt lgkmcnt(0)
    v_exp_f32 v76, v76
    v_exp_f32 v77, v77
    v_exp_f32 v78, v78
    v_exp_f32 v79, v79
    v_cvt_pk_bf16_f32 v136, v76, v77
    v_cvt_pk_bf16_f32 v137, v78, v79
    v_mfma_f32_32x32x16_bf16 v[100:115], v[60:63], v[132:135], v[100:115]
    ds_read_b128 v[52:55], v11 offset:4096
    v_exp_f32 v80, v80
    v_exp_f32 v81, v81
    v_exp_f32 v82, v82
    v_exp_f32 v83, v83
    v_cvt_pk_bf16_f32 v138, v80, v81
    v_cvt_pk_bf16_f32 v139, v82, v83
    v_mfma_f32_32x32x16_bf16 v[68:83], v[36:39], v[16:19], 0
    ds_read_b128 v[56:59], v11 offset:5120
    v_exp_f32 v84, v84
    v_exp_f32 v85, v85
    v_exp_f32 v86, v86
    v_exp_f32 v87, v87
    v_cvt_pk_bf16_f32 v132, v84, v85
    v_cvt_pk_bf16_f32 v133, v86, v87
    v_mfma_f32_32x32x8_bf16 v[68:83], v[48:49], v[24:25], v[68:83]
    s_setprio 0
    s_add_u32 s33, s3, 23089152
    s_cmp_eq_u32 s14, 0
    s_cselect_b32 s43, s43, s33
    s_mov_b32 s33, 122880
    s_cselect_b32 s33, 49152, s33
    v_exp_f32 v88, v88
    v_exp_f32 v89, v89
    v_exp_f32 v90, v90
    v_exp_f32 v91, v91
    v_cvt_pk_bf16_f32 v134, v88, v89
    v_cvt_pk_bf16_f32 v135, v90, v91
    v_mfma_f32_32x32x16_bf16 v[100:115], v[64:67], v[136:139], v[100:115]
    s_add_u32 s33, s33, s43
    v_exp_f32 v92, v92
    v_exp_f32 v93, v93
    v_exp_f32 v94, v94
    v_exp_f32 v95, v95
    v_cvt_pk_bf16_f32 v136, v92, v93
    v_cvt_pk_bf16_f32 v137, v94, v95
    v_mfma_f32_32x32x16_bf16 v[116:131], v[60:63], v[132:135], v[116:131]
    s_sub_u32 s17, s12, 1
    s_add_u32 s18, s23, s23
    s_or_b32 s17, s17, s18
    s_cmp_lt_u32 s17, 2
    s_cbranch_scc1 F_full
F_fullx:
    s_waitcnt vmcnt(0)
    s_barrier
    s_getreg_b32 s65, hwreg(HW_REG_XCC_ID)
    s_add_u32 s65, s65, 1
    s_lshl_b32 s17, s66, 7
    s_lshl2_add_u32 s17, s67, s17
    s_add_u32 s17, s17, 19488768
    v_mov_b32 v12, 0
    v_mov_b32 v13, s65
    s_cmp_eq_u32 s12, 4
    s_cselect_b32 s17, s17, 0x40000000
    s_mov_b64 exec, 1
    buffer_store_dword v13, v12, s[8:11], s17 offen sc1
    s_mov_b64 exec, -1
    v_exp_f32 v96, v96
    v_exp_f32 v97, v97
    v_exp_f32 v98, v98
    v_exp_f32 v99, v99
    v_cvt_pk_bf16_f32 v138, v96, v97
    v_cvt_pk_bf16_f32 v139, v98, v99
    v_mfma_f32_32x32x16_bf16 v[84:99], v[36:39], v[20:23], 0
    s_add_u32 m0, s29, 26624
    s_add_u32 s18, s26, 0
    buffer_load_dwordx4 v7, s[8:11], s18 offen sc1 lds
    v_exp_f32 v68, v68
    v_exp_f32 v69, v69
    v_exp_f32 v70, v70
    v_exp_f32 v71, v71
    v_cvt_pk_bf16_f32 v132, v68, v69
    v_cvt_pk_bf16_f32 v133, v70, v71
    v_mfma_f32_32x32x8_bf16 v[84:99], v[48:49], v[26:27], v[84:99]
    s_setprio 3
    s_add_u32 m0, s32, 30720
    s_add_u32 s18, s27, 65536
    s_mov_b64 exec, s[36:37]
    buffer_load_dwordx4 v7, s[8:11], s18 offen sc1 lds
    s_mov_b64 exec, -1
    v_exp_f32 v72, v72
    v_exp_f32 v73, v73
    v_exp_f32 v74, v74
    v_exp_f32 v75, v75
    v_cvt_pk_bf16_f32 v134, v72, v73
    v_cvt_pk_bf16_f32 v135, v74, v75
    v_mfma_f32_32x32x16_bf16 v[116:131], v[64:67], v[136:139], v[116:131]
    s_waitcnt lgkmcnt(0)
    v_exp_f32 v76, v76
    v_exp_f32 v77, v77
    v_exp_f32 v78, v78
    v_exp_f32 v79, v79
    v_cvt_pk_bf16_f32 v136, v76, v77
    v_cvt_pk_bf16_f32 v137, v78, v79
    v_mfma_f32_32x32x16_bf16 v[100:115], v[52:55], v[132:135], v[100:115]
    ds_read_b128 v[60:63], v11 offset:6144
    v_exp_f32 v80, v80
    v_exp_f32 v81, v81
    v_exp_f32 v82, v82
    v_exp_f32 v83, v83
    v_cvt_pk_bf16_f32 v138, v80, v81
    v_cvt_pk_bf16_f32 v139, v82, v83
    v_mfma_f32_32x32x16_bf16 v[68:83], v[40:43], v[16:19], 0
    ds_read_b128 v[64:67], v11 offset:7168
    v_exp_f32 v84, v84
    v_exp_f32 v85, v85
    v_exp_f32 v86, v86
    v_exp_f32 v87, v87
    v_cvt_pk_bf16_f32 v132, v84, v85
    v_cvt_pk_bf16_f32 v133, v86, v87
    v_add_u32 v9, 0x3400, v9
    v_add_u32 v10, 0x3400, v10
    v_mfma_f32_32x32x8_bf16 v[68:83], v[50:51], v[24:25], v[68:83]
    ds_read2_b64 v[28:31], v9 offset0:0 offset1:128
    v_exp_f32 v88, v88
    v_exp_f32 v89, v89
    v_exp_f32 v90, v90
    v_exp_f32 v91, v91
    v_cvt_pk_bf16_f32 v134, v88, v89
    v_cvt_pk_bf16_f32 v135, v90, v91
    v_mfma_f32_32x32x16_bf16 v[100:115], v[56:59], v[136:139], v[100:115]
    ds_read2_b64 v[32:35], v9 offset0:1 offset1:129
    v_exp_f32 v92, v92
    v_exp_f32 v93, v93
    v_exp_f32 v94, v94
    v_exp_f32 v95, v95
    v_cvt_pk_bf16_f32 v136, v92, v93
    v_cvt_pk_bf16_f32 v137, v94, v95
    v_mfma_f32_32x32x16_bf16 v[116:131], v[52:55], v[132:135], v[116:131]
    ds_read_b128 v[44:47], v10 offset:0
    v_exp_f32 v96, v96
    v_exp_f32 v97, v97
    v_exp_f32 v98, v98
    v_exp_f32 v99, v99
    v_cvt_pk_bf16_f32 v138, v96, v97
    v_cvt_pk_bf16_f32 v139, v98, v99
    v_mfma_f32_32x32x16_bf16 v[84:99], v[40:43], v[20:23], 0
    s_add_u32 m0, s31, 31744
    s_add_u32 s18, s28, 5242880
    s_mov_b64 exec, s[34:35]
    buffer_load_dwordx4 v8, s[8:11], s18 offen sc1 lds
    s_add_u32 m0, m0, 1024
    s_add_u32 s18, s18, 20480
    buffer_load_dwordx4 v8, s[8:11], s18 offen sc1 lds
    s_mov_b64 exec, -1
    v_exp_f32 v68, v68
    v_exp_f32 v69, v69
    v_exp_f32 v70, v70
    v_exp_f32 v71, v71
    v_cvt_pk_bf16_f32 v132, v68, v69
    v_cvt_pk_bf16_f32 v133, v70, v71
    v_mfma_f32_32x32x8_bf16 v[84:99], v[50:51], v[26:27], v[84:99]
    s_setprio 2
    v_exp_f32 v72, v72
    v_exp_f32 v73, v73
    v_exp_f32 v74, v74
    v_exp_f32 v75, v75
    v_cvt_pk_bf16_f32 v134, v72, v73
    v_cvt_pk_bf16_f32 v135, v74, v75
    v_mfma_f32_32x32x16_bf16 v[116:131], v[56:59], v[136:139], v[116:131]
    s_waitcnt lgkmcnt(0)
    v_exp_f32 v76, v76
    v_exp_f32 v77, v77
    v_exp_f32 v78, v78
    v_exp_f32 v79, v79
    v_cvt_pk_bf16_f32 v136, v76, v77
    v_cvt_pk_bf16_f32 v137, v78, v79
    v_add_u32 v11, 0x3400, v11
    v_mfma_f32_32x32x16_bf16 v[100:115], v[60:63], v[132:135], v[100:115]
    ds_read_b128 v[52:55], v11 offset:0
    v_exp_f32 v80, v80
    v_exp_f32 v81, v81
    v_exp_f32 v82, v82
    v_exp_f32 v83, v83
    v_cvt_pk_bf16_f32 v138, v80, v81
    v_cvt_pk_bf16_f32 v139, v82, v83
    v_mfma_f32_32x32x16_bf16 v[68:83], v[28:31], v[16:19], 0
    ds_read_b128 v[56:59], v11 offset:1024
    v_exp_f32 v84, v84
    v_exp_f32 v85, v85
    v_exp_f32 v86, v86
    v_exp_f32 v87, v87
    v_cvt_pk_bf16_f32 v132, v84, v85
    v_cvt_pk_bf16_f32 v133, v86, v87
    v_mfma_f32_32x32x8_bf16 v[68:83], v[44:45], v[24:25], v[68:83]
    v_exp_f32 v88, v88
    v_exp_f32 v89, v89
    v_exp_f32 v90, v90
    v_exp_f32 v91, v91
    v_cvt_pk_bf16_f32 v134, v88, v89
    v_cvt_pk_bf16_f32 v135, v90, v91
    v_mfma_f32_32x32x16_bf16 v[100:115], v[64:67], v[136:139], v[100:115]
    v_exp_f32 v92, v92
    v_exp_f32 v93, v93
    v_exp_f32 v94, v94
    v_exp_f32 v95, v95
    v_cvt_pk_bf16_f32 v136, v92, v93
    v_cvt_pk_bf16_f32 v137, v94, v95
    v_mfma_f32_32x32x16_bf16 v[116:131], v[60:63], v[132:135], v[116:131]
    v_exp_f32 v96, v96
    v_exp_f32 v97, v97
    v_exp_f32 v98, v98
    v_exp_f32 v99, v99
    v_cvt_pk_bf16_f32 v138, v96, v97
    v_cvt_pk_bf16_f32 v139, v98, v99
    v_mfma_f32_32x32x16_bf16 v[84:99], v[28:31], v[20:23], 0
    s_add_u32 m0, s29, 39936
    s_add_u32 s18, s26, 1024
    buffer_load_dwordx4 v7, s[8:11], s18 offen sc1 lds
    v_exp_f32 v68, v68
    v_exp_f32 v69, v69
    v_exp_f32 v70, v70
    v_exp_f32 v71, v71
    v_cvt_pk_bf16_f32 v132, v68, v69
    v_cvt_pk_bf16_f32 v133, v70, v71
    v_mfma_f32_32x32x8_bf16 v[84:99], v[44:45], v[26:27], v[84:99]
    s_setprio 1
    s_add_u32 m0, s32, 44032
    s_add_u32 s18, s27, 66560
    s_mov_b64 exec, s[36:37]
    buffer_load_dwordx4 v7, s[8:11], s18 offen sc1 lds
    s_mov_b64 exec, -1
    v_exp_f32 v72, v72
    v_exp_f32 v73, v73
    v_exp_f32 v74, v74
    v_exp_f32 v75, v75
    v_cvt_pk_bf16_f32 v134, v72, v73
    v_cvt_pk_bf16_f32 v135, v74, v75
    v_mfma_f32_32x32x16_bf16 v[116:131], v[64:67], v[136:139], v[116:131]
    s_waitcnt lgkmcnt(0)
    v_exp_f32 v76, v76
    v_exp_f32 v77, v77
    v_exp_f32 v78, v78
    v_exp_f32 v79, v79
    v_cvt_pk_bf16_f32 v136, v76, v77
    v_cvt_pk_bf16_f32 v137, v78, v79
    v_mfma_f32_32x32x16_bf16 v[100:115], v[52:55], v[132:135], v[100:115]
    ds_read_b128 v[60:63], v11 offset:2048
    v_exp_f32 v80, v80
    v_exp_f32 v81, v81
    v_exp_f32 v82, v82
    v_exp_f32 v83, v83
    v_cvt_pk_bf16_f32 v138, v80, v81
    v_cvt_pk_bf16_f32 v139, v82, v83
    v_mfma_f32_32x32x16_bf16 v[68:83], v[32:35], v[16:19], 0
    ds_read_b128 v[64:67], v11 offset:3072
    v_exp_f32 v84, v84
    v_exp_f32 v85, v85
    v_exp_f32 v86, v86
    v_exp_f32 v87, v87
    v_cvt_pk_bf16_f32 v132, v84, v85
    v_cvt_pk_bf16_f32 v133, v86, v87
    v_mfma_f32_32x32x8_bf16 v[68:83], v[46:47], v[24:25], v[68:83]
    ds_read2_b64 v[36:39], v9 offset0:64 offset1:192
    v_exp_f32 v88, v88
    v_exp_f32 v89, v89
    v_exp_f32 v90, v90
    v_exp_f32 v91, v91
    v_cvt_pk_bf16_f32 v134, v88, v89
    v_cvt_pk_bf16_f32 v135, v90, v91
    v_mfma_f32_32x32x16_bf16 v[100:115], v[56:59], v[136:139], v[100:115]
    ds_read2_b64 v[40:43], v9 offset0:65 offset1:193
    v_exp_f32 v92, v92
    v_exp_f32 v93, v93
    v_exp_f32 v94, v94
    v_exp_f32 v95, v95
    v_cvt_pk_bf16_f32 v136, v92, v93
    v_cvt_pk_bf16_f32 v137, v94, v95
    v_mfma_f32_32x32x16_bf16 v[116:131], v[52:55], v[132:135], v[116:131]
    ds_read_b128 v[48:51], v10 offset:512
    v_exp_f32 v96, v96
    v_exp_f32 v97, v97
    v_exp_f32 v98, v98
    v_exp_f32 v99, v99
    v_cvt_pk_bf16_f32 v138, v96, v97
    v_cvt_pk_bf16_f32 v139, v98, v99
    v_mfma_f32_32x32x16_bf16 v[84:99], v[32:35], v[20:23], 0
    s_add_u32 m0, s31, 45056
    s_add_u32 s18, s28, 5406720
    s_mov_b64 exec, s[34:35]
    buffer_load_dwordx4 v8, s[8:11], s18 offen sc1 lds
    s_add_u32 m0, m0, 1024
    s_add_u32 s18, s18, 20480
    buffer_load_dwordx4 v8, s[8:11], s18 offen sc1 lds
    s_mov_b64 exec, -1
    v_exp_f32 v68, v68
    v_exp_f32 v69, v69
    v_exp_f32 v70, v70
    v_exp_f32 v71, v71
    v_cvt_pk_bf16_f32 v132, v68, v69
    v_cvt_pk_bf16_f32 v133, v70, v71
    v_mfma_f32_32x32x8_bf16 v[84:99], v[46:47], v[26:27], v[84:99]
    s_setprio 0
    s_mul_i32 s22, s57, 102400
    s_mul_i32 s71, s14, 51200
    v_exp_f32 v72, v72
    v_exp_f32 v73, v73
    v_exp_f32 v74, v74
    v_exp_f32 v75, v75
    v_cvt_pk_bf16_f32 v134, v72, v73
    v_cvt_pk_bf16_f32 v135, v74, v75
    v_mfma_f32_32x32x16_bf16 v[116:131], v[56:59], v[136:139], v[116:131]
    s_waitcnt lgkmcnt(0)
    v_exp_f32 v76, v76
    v_exp_f32 v77, v77
    v_exp_f32 v78, v78
    v_exp_f32 v79, v79
    v_cvt_pk_bf16_f32 v136, v76, v77
    v_cvt_pk_bf16_f32 v137, v78, v79
    v_mfma_f32_32x32x16_bf16 v[100:115], v[60:63], v[132:135], v[100:115]
    ds_read_b128 v[52:55], v11 offset:4096
    v_exp_f32 v80, v80
    v_exp_f32 v81, v81
    v_exp_f32 v82, v82
    v_exp_f32 v83, v83
    v_cvt_pk_bf16_f32 v138, v80, v81
    v_cvt_pk_bf16_f32 v139, v82, v83
    v_mfma_f32_32x32x16_bf16 v[68:83], v[36:39], v[16:19], 0
    ds_read_b128 v[56:59], v11 offset:5120
    v_exp_f32 v84, v84
    v_exp_f32 v85, v85
    v_exp_f32 v86, v86
    v_exp_f32 v87, v87
    v_cvt_pk_bf16_f32 v132, v84, v85
    v_cvt_pk_bf16_f32 v133, v86, v87
    v_mfma_f32_32x32x8_bf16 v[68:83], v[48:49], v[24:25], v[68:83]
    s_add_u32 s22, s22, s71
    s_add_u32 s22, s22, s30
    v_exp_f32 v88, v88
    v_exp_f32 v89, v89
    v_exp_f32 v90, v90
    v_exp_f32 v91, v91
    v_cvt_pk_bf16_f32 v134, v88, v89
    v_cvt_pk_bf16_f32 v135, v90, v91
    v_mfma_f32_32x32x16_bf16 v[100:115], v[64:67], v[136:139], v[100:115]
    s_add_u32 s22, s22, 19922944
    v_exp_f32 v92, v92
    v_exp_f32 v93, v93
    v_exp_f32 v94, v94
    v_exp_f32 v95, v95
    v_cvt_pk_bf16_f32 v136, v92, v93
    v_cvt_pk_bf16_f32 v137, v94, v95
    v_mfma_f32_32x32x16_bf16 v[116:131], v[60:63], v[132:135], v[116:131]
    s_waitcnt vmcnt(4)
    s_barrier
    v_exp_f32 v96, v96
    v_exp_f32 v97, v97
    v_exp_f32 v98, v98
    v_exp_f32 v99, v99
    v_cvt_pk_bf16_f32 v138, v96, v97
    v_cvt_pk_bf16_f32 v139, v98, v99
    v_mfma_f32_32x32x16_bf16 v[84:99], v[36:39], v[20:23], 0
    s_add_u32 m0, s29, 53248
    s_add_u32 s18, s26, 2048
    buffer_load_dwordx4 v7, s[8:11], s18 offen sc1 lds
    v_exp_f32 v68, v68
    v_exp_f32 v69, v69
    v_exp_f32 v70, v70
    v_exp_f32 v71, v71
    v_cvt_pk_bf16_f32 v132, v68, v69
    v_cvt_pk_bf16_f32 v133, v70, v71
    v_mfma_f32_32x32x8_bf16 v[84:99], v[48:49], v[26:27], v[84:99]
    s_setprio 3
    s_add_u32 m0, s32, 57344
    s_add_u32 s18, s27, 67584
    s_mov_b64 exec, s[36:37]
    buffer_load_dwordx4 v7, s[8:11], s18 offen sc1 lds
    s_mov_b64 exec, -1
    v_exp_f32 v72, v72
    v_exp_f32 v73, v73
    v_exp_f32 v74, v74
    v_exp_f32 v75, v75
    v_cvt_pk_bf16_f32 v134, v72, v73
    v_cvt_pk_bf16_f32 v135, v74, v75
    v_mfma_f32_32x32x16_bf16 v[116:131], v[64:67], v[136:139], v[116:131]
    s_waitcnt lgkmcnt(0)
    v_exp_f32 v76, v76
    v_exp_f32 v77, v77
    v_exp_f32 v78, v78
    v_exp_f32 v79, v79
    v_cvt_pk_bf16_f32 v136, v76, v77
    v_cvt_pk_bf16_f32 v137, v78, v79
    v_mfma_f32_32x32x16_bf16 v[100:115], v[52:55], v[132:135], v[100:115]
    ds_read_b128 v[60:63], v11 offset:6144
    v_exp_f32 v80, v80
    v_exp_f32 v81, v81
    v_exp_f32 v82, v82
    v_exp_f32 v83, v83
    v_cvt_pk_bf16_f32 v138, v80, v81
    v_cvt_pk_bf16_f32 v139, v82, v83
    v_mfma_f32_32x32x16_bf16 v[68:83], v[40:43], v[16:19], 0
    ds_read_b128 v[64:67], v11 offset:7168
    v_exp_f32 v84, v84
    v_exp_f32 v85, v85
    v_exp_f32 v86, v86
    v_exp_f32 v87, v87
    v_cvt_pk_bf16_f32 v132, v84, v85
    v_cvt_pk_bf16_f32 v133, v86, v87
    v_add_u32 v9, 0x3400, v9
    v_add_u32 v10, 0x3400, v10
    v_mfma_f32_32x32x8_bf16 v[68:83], v[50:51], v[24:25], v[68:83]
    ds_read2_b64 v[28:31], v9 offset0:0 offset1:128
    v_exp_f32 v88, v88
    v_exp_f32 v89, v89
    v_exp_f32 v90, v90
    v_exp_f32 v91, v91
    v_cvt_pk_bf16_f32 v134, v88, v89
    v_cvt_pk_bf16_f32 v135, v90, v91
    v_mfma_f32_32x32x16_bf16 v[100:115], v[56:59], v[136:139], v[100:115]
    ds_read2_b64 v[32:35], v9 offset0:1 offset1:129
    v_exp_f32 v92, v92
    v_exp_f32 v93, v93
    v_exp_f32 v94, v94
    v_exp_f32 v95, v95
    v_cvt_pk_bf16_f32 v136, v92, v93
    v_cvt_pk_bf16_f32 v137, v94, v95
    v_mfma_f32_32x32x16_bf16 v[116:131], v[52:55], v[132:135], v[116:131]
    ds_read_b128 v[44:47], v10 offset:0
    v_exp_f32 v96, v96
    v_exp_f32 v97, v97
    v_exp_f32 v98, v98
    v_exp_f32 v99, v99
    v_cvt_pk_bf16_f32 v138, v96, v97
    v_cvt_pk_bf16_f32 v139, v98, v99
    v_mfma_f32_32x32x16_bf16 v[84:99], v[40:43], v[20:23], 0
    s_add_u32 m0, s31, 58368
    s_add_u32 s18, s28, 5570560
    s_mov_b64 exec, s[34:35]
    buffer_load_dwordx4 v8, s[8:11], s18 offen sc1 lds
    s_add_u32 m0, m0, 1024
    s_add_u32 s18, s18, 20480
    buffer_load_dwordx4 v8, s[8:11], s18 offen sc1 lds
    s_mov_b64 exec, -1
    v_exp_f32 v68, v68
    v_exp_f32 v69, v69
    v_exp_f32 v70, v70
    v_exp_f32 v71, v71
    v_cvt_pk_bf16_f32 v132, v68, v69
    v_cvt_pk_bf16_f32 v133, v70, v71
    v_mfma_f32_32x32x8_bf16 v[84:99], v[50:51], v[26:27], v[84:99]
    s_setprio 2
    v_and_b32 v4, 31, v1
    v_lshlrev_b32 v4, 7, v4
    s_lshl_b32 s61, s12, 12
    s_add_u32 s61, s61, 19529728
    s_cmp_eq_u32 s12, 99
    s_cselect_b32 s16, 0x55555555, -1
    s_mov_b32 exec_lo, s16
    s_mov_b32 exec_hi, 0
    buffer_load_dwordx4 v[252:255], v4, s[8:11], s61 offen sc1
    s_mov_b64 exec, -1
    v_exp_f32 v72, v72
    v_exp_f32 v73, v73
    v_exp_f32 v74, v74
    v_exp_f32 v75, v75
    v_cvt_pk_bf16_f32 v134, v72, v73
    v_cvt_pk_bf16_f32 v135, v74, v75
    v_mfma_f32_32x32x16_bf16 v[116:131], v[56:59], v[136:139], v[116:131]
    s_waitcnt lgkmcnt(0)
    v_exp_f32 v76, v76
    v_exp_f32 v77, v77
    v_exp_f32 v78, v78
    v_exp_f32 v79, v79
    v_cvt_pk_bf16_f32 v136, v76, v77
    v_cvt_pk_bf16_f32 v137, v78, v79
    v_add_u32 v11, 0x3400, v11
    v_mfma_f32_32x32x16_bf16 v[100:115], v[60:63], v[132:135], v[100:115]
    ds_read_b128 v[52:55], v11 offset:0
    v_exp_f32 v80, v80
    v_exp_f32 v81, v81
    v_exp_f32 v82, v82
    v_exp_f32 v83, v83
    v_cvt_pk_bf16_f32 v138, v80, v81
    v_cvt_pk_bf16_f32 v139, v82, v83
    v_mfma_f32_32x32x16_bf16 v[68:83], v[28:31], v[16:19], 0
    ds_read_b128 v[56:59], v11 offset:1024
    v_exp_f32 v84, v84
    v_exp_f32 v85, v85
    v_exp_f32 v86, v86
    v_exp_f32 v87, v87
    v_cvt_pk_bf16_f32 v132, v84, v85
    v_cvt_pk_bf16_f32 v133, v86, v87
    v_mfma_f32_32x32x8_bf16 v[68:83], v[44:45], v[24:25], v[68:83]
    v_exp_f32 v88, v88
    v_exp_f32 v89, v89
    v_exp_f32 v90, v90
    v_exp_f32 v91, v91
    v_cvt_pk_bf16_f32 v134, v88, v89
    v_cvt_pk_bf16_f32 v135, v90, v91
    v_mfma_f32_32x32x16_bf16 v[100:115], v[64:67], v[136:139], v[100:115]
    v_exp_f32 v92, v92
    v_exp_f32 v93, v93
    v_exp_f32 v94, v94
    v_exp_f32 v95, v95
    v_cvt_pk_bf16_f32 v136, v92, v93
    v_cvt_pk_bf16_f32 v137, v94, v95
    v_mfma_f32_32x32x16_bf16 v[116:131], v[60:63], v[132:135], v[116:131]
    v_exp_f32 v96, v96
    v_exp_f32 v97, v97
    v_exp_f32 v98, v98
    v_exp_f32 v99, v99
    v_cvt_pk_bf16_f32 v138, v96, v97
    v_cvt_pk_bf16_f32 v139, v98, v99
    v_mfma_f32_32x32x16_bf16 v[84:99], v[28:31], v[20:23], 0
    s_lshl_b32 s64, s66, 3
    s_lshl1_add_u32 s64, s13, s64
    v_exp_f32 v68, v68
    v_exp_f32 v69, v69
    v_exp_f32 v70, v70
    v_exp_f32 v71, v71
    v_cvt_pk_bf16_f32 v132, v68, v69
    v_cvt_pk_bf16_f32 v133, v70, v71
    v_mfma_f32_32x32x8_bf16 v[84:99], v[44:45], v[26:27], v[84:99]
    s_setprio 1
    s_add_u32 s64, s64, s14
    s_mul_i32 s68, s64, 40960
    v_exp_f32 v72, v72
    v_exp_f32 v73, v73
    v_exp_f32 v74, v74
    v_exp_f32 v75, v75
    v_cvt_pk_bf16_f32 v134, v72, v73
    v_cvt_pk_bf16_f32 v135, v74, v75
    v_mfma_f32_32x32x16_bf16 v[116:131], v[64:67], v[136:139], v[116:131]
    s_waitcnt lgkmcnt(0)
    v_exp_f32 v76, v76
    v_exp_f32 v77, v77
    v_exp_f32 v78, v78
    v_exp_f32 v79, v79
    v_cvt_pk_bf16_f32 v136, v76, v77
    v_cvt_pk_bf16_f32 v137, v78, v79
    v_mfma_f32_32x32x16_bf16 v[100:115], v[52:55], v[132:135], v[100:115]
    ds_read_b128 v[60:63], v11 offset:2048
    v_exp_f32 v80, v80
    v_exp_f32 v81, v81
    v_exp_f32 v82, v82
    v_exp_f32 v83, v83
    v_cvt_pk_bf16_f32 v138, v80, v81
    v_cvt_pk_bf16_f32 v139, v82, v83
    v_mfma_f32_32x32x16_bf16 v[68:83], v[32:35], v[16:19], 0
    ds_read_b128 v[64:67], v11 offset:3072
    v_exp_f32 v84, v84
    v_exp_f32 v85, v85
    v_exp_f32 v86, v86
    v_exp_f32 v87, v87
    v_cvt_pk_bf16_f32 v132, v84, v85
    v_cvt_pk_bf16_f32 v133, v86, v87
    v_mfma_f32_32x32x8_bf16 v[68:83], v[46:47], v[24:25], v[68:83]
    ds_read2_b64 v[36:39], v9 offset0:64 offset1:192
    v_exp_f32 v88, v88
    v_exp_f32 v89, v89
    v_exp_f32 v90, v90
    v_exp_f32 v91, v91
    v_cvt_pk_bf16_f32 v134, v88, v89
    v_cvt_pk_bf16_f32 v135, v90, v91
    v_mfma_f32_32x32x16_bf16 v[100:115], v[56:59], v[136:139], v[100:115]
    ds_read2_b64 v[40:43], v9 offset0:65 offset1:193
    v_exp_f32 v92, v92
    v_exp_f32 v93, v93
    v_exp_f32 v94, v94
    v_exp_f32 v95, v95
    v_cvt_pk_bf16_f32 v136, v92, v93
    v_cvt_pk_bf16_f32 v137, v94, v95
    v_mfma_f32_32x32x16_bf16 v[116:131], v[52:55], v[132:135], v[116:131]
    ds_read_b128 v[48:51], v10 offset:512
    v_exp_f32 v96, v96
    v_exp_f32 v97, v97
    v_exp_f32 v98, v98
    v_exp_f32 v99, v99
    v_cvt_pk_bf16_f32 v138, v96, v97
    v_cvt_pk_bf16_f32 v139, v98, v99
    v_mfma_f32_32x32x16_bf16 v[84:99], v[32:35], v[20:23], 0
    s_lshr_b32 s60, s67, 3
    s_mul_i32 s60, s60, 5120
    v_exp_f32 v68, v68
    v_exp_f32 v69, v69
    v_exp_f32 v70, v70
    v_exp_f32 v71, v71
    v_cvt_pk_bf16_f32 v132, v68, v69
    v_cvt_pk_bf16_f32 v133, v70, v71
    v_mfma_f32_32x32x8_bf16 v[84:99], v[46:47], v[26:27], v[84:99]
    s_setprio 0
    s_add_u32 s68, s68, s60
    s_add_u32 s68, s68, 7864320
    v_exp_f32 v72, v72
    v_exp_f32 v73, v73
    v_exp_f32 v74, v74
    v_exp_f32 v75, v75
    v_cvt_pk_bf16_f32 v134, v72, v73
    v_cvt_pk_bf16_f32 v135, v74, v75
    v_mfma_f32_32x32x16_bf16 v[116:131], v[56:59], v[136:139], v[116:131]
    s_waitcnt lgkmcnt(0)
    v_exp_f32 v76, v76
    v_exp_f32 v77, v77
    v_exp_f32 v78, v78
    v_exp_f32 v79, v79
    v_cvt_pk_bf16_f32 v136, v76, v77
    v_cvt_pk_bf16_f32 v137, v78, v79
    v_mfma_f32_32x32x16_bf16 v[100:115], v[60:63], v[132:135], v[100:115]
    ds_read_b128 v[52:55], v11 offset:4096
    v_exp_f32 v80, v80
    v_exp_f32 v81, v81
    v_exp_f32 v82, v82
    v_exp_f32 v83, v83
    v_cvt_pk_bf16_f32 v138, v80, v81
    v_cvt_pk_bf16_f32 v139, v82, v83
    v_mfma_f32_32x32x16_bf16 v[68:83], v[36:39], v[16:19], 0
    ds_read_b128 v[56:59], v11 offset:5120
    v_exp_f32 v84, v84
    v_exp_f32 v85, v85
    v_exp_f32 v86, v86
    v_exp_f32 v87, v87
    v_cvt_pk_bf16_f32 v132, v84, v85
    v_cvt_pk_bf16_f32 v133, v86, v87
    v_mfma_f32_32x32x8_bf16 v[68:83], v[48:49], v[24:25], v[68:83]
    s_and_b32 s60, s67, 7
    s_lshl_b32 s60, s60, 9
    v_exp_f32 v88, v88
    v_exp_f32 v89, v89
    v_exp_f32 v90, v90
    v_exp_f32 v91, v91
    v_cvt_pk_bf16_f32 v134, v88, v89
    v_cvt_pk_bf16_f32 v135, v90, v91
    v_mfma_f32_32x32x16_bf16 v[100:115], v[64:67], v[136:139], v[100:115]
    s_waitcnt vmcnt(0)
    v_and_b32 v252, v252, v253
    v_and_b32 v254, v254, v255
    v_and_b32 v252, v252, v254
    s_mov_b32 exec_lo, s16
    s_mov_b32 exec_hi, 0
    v_cmp_ne_u32 vcc, 1, v252
    s_mov_b64 exec, -1
    s_cbranch_vccnz F_wspin
F_wok:
    v_exp_f32 v92, v92
    v_exp_f32 v93, v93
    v_exp_f32 v94, v94
    v_exp_f32 v95, v95
    v_cvt_pk_bf16_f32 v136, v92, v93
    v_cvt_pk_bf16_f32 v137, v94, v95
    v_mfma_f32_32x32x16_bf16 v[116:131], v[60:63], v[132:135], v[116:131]
    s_waitcnt vmcnt(1)
    s_barrier
    v_exp_f32 v96, v96
    v_exp_f32 v97, v97
    v_exp_f32 v98, v98
    v_exp_f32 v99, v99
    v_cvt_pk_bf16_f32 v138, v96, v97
    v_cvt_pk_bf16_f32 v139, v98, v99
    v_mfma_f32_32x32x16_bf16 v[84:99], v[36:39], v[20:23], 0
    s_add_u32 m0, s29, 66560
    s_add_u32 s18, s26, 4096
    buffer_load_dwordx4 v7, s[8:11], s18 offen sc1 lds
    v_exp_f32 v68, v68
    v_exp_f32 v69, v69
    v_exp_f32 v70, v70
    v_exp_f32 v71, v71
    v_cvt_pk_bf16_f32 v132, v68, v69
    v_cvt_pk_bf16_f32 v133, v70, v71
    v_mfma_f32_32x32x8_bf16 v[84:99], v[48:49], v[26:27], v[84:99]
    s_setprio 3
    s_add_u32 m0, s32, 70656
    s_add_u32 s18, s27, 69632
    s_mov_b64 exec, s[36:37]
    buffer_load_dwordx4 v7, s[8:11], s18 offen sc1 lds
    s_mov_b64 exec, -1
    v_exp_f32 v72, v72
    v_exp_f32 v73, v73
    v_exp_f32 v74, v74
    v_exp_f32 v75, v75
    v_cvt_pk_bf16_f32 v134, v72, v73
    v_cvt_pk_bf16_f32 v135, v74, v75
    v_mfma_f32_32x32x16_bf16 v[116:131], v[64:67], v[136:139], v[116:131]
    s_waitcnt lgkmcnt(0)
    v_exp_f32 v76, v76
    v_exp_f32 v77, v77
    v_exp_f32 v78, v78
    v_exp_f32 v79, v79
    v_cvt_pk_bf16_f32 v136, v76, v77
    v_cvt_pk_bf16_f32 v137, v78, v79
    v_mfma_f32_32x32x16_bf16 v[100:115], v[52:55], v[132:135], v[100:115]
    ds_read_b128 v[60:63], v11 offset:6144
    v_exp_f32 v80, v80
    v_exp_f32 v81, v81
    v_exp_f32 v82, v82
    v_exp_f32 v83, v83
    v_cvt_pk_bf16_f32 v138, v80, v81
    v_cvt_pk_bf16_f32 v139, v82, v83
    v_mfma_f32_32x32x16_bf16 v[68:83], v[40:43], v[16:19], 0
    ds_read_b128 v[64:67], v11 offset:7168
    v_exp_f32 v84, v84
    v_exp_f32 v85, v85
    v_exp_f32 v86, v86
    v_exp_f32 v87, v87
    v_cvt_pk_bf16_f32 v132, v84, v85
    v_cvt_pk_bf16_f32 v133, v86, v87
    v_add_u32 v9, 0x3400, v9
    v_add_u32 v10, 0x3400, v10
    v_mfma_f32_32x32x8_bf16 v[68:83], v[50:51], v[24:25], v[68:83]
    ds_read2_b64 v[28:31], v9 offset0:0 offset1:128
    v_exp_f32 v88, v88
    v_exp_f32 v89, v89
    v_exp_f32 v90, v90
    v_exp_f32 v91, v91
    v_cvt_pk_bf16_f32 v134, v88, v89
    v_cvt_pk_bf16_f32 v135, v90, v91
    v_mfma_f32_32x32x16_bf16 v[100:115], v[56:59], v[136:139], v[100:115]
    ds_read2_b64 v[32:35], v9 offset0:1 offset1:129
    v_exp_f32 v92, v92
    v_exp_f32 v93, v93
    v_exp_f32 v94, v94
    v_exp_f32 v95, v95
    v_cvt_pk_bf16_f32 v136, v92, v93
    v_cvt_pk_bf16_f32 v137, v94, v95
    v_mfma_f32_32x32x16_bf16 v[116:131], v[52:55], v[132:135], v[116:131]
    ds_read_b128 v[44:47], v10 offset:0
    v_exp_f32 v96, v96
    v_exp_f32 v97, v97
    v_exp_f32 v98, v98
    v_exp_f32 v99, v99
    v_cvt_pk_bf16_f32 v138, v96, v97
    v_cvt_pk_bf16_f32 v139, v98, v99
    v_mfma_f32_32x32x16_bf16 v[84:99], v[40:43], v[20:23], 0
    s_add_u32 m0, s31, 71680
    s_add_u32 s18, s28, 5898240
    s_mov_b64 exec, s[34:35]
    buffer_load_dwordx4 v8, s[8:11], s18 offen sc1 lds
    s_add_u32 m0, m0, 1024
    s_add_u32 s18, s18, 20480
    buffer_load_dwordx4 v8, s[8:11], s18 offen sc1 lds
    s_mov_b64 exec, -1
    v_exp_f32 v68, v68
    v_exp_f32 v69, v69
    v_exp_f32 v70, v70
    v_exp_f32 v71, v71
    v_cvt_pk_bf16_f32 v132, v68, v69
    v_cvt_pk_bf16_f32 v133, v70, v71
    v_mfma_f32_32x32x8_bf16 v[84:99], v[50:51], v[26:27], v[84:99]
    s_add_u32 s18, s43, 0
    buffer_load_dwordx4 v[160:163], v7, s[8:11], s18 offen
    v_exp_f32 v72, v72
    v_exp_f32 v73, v73
    v_exp_f32 v74, v74
    v_exp_f32 v75, v75
    v_cvt_pk_bf16_f32 v134, v72, v73
    v_cvt_pk_bf16_f32 v135, v74, v75
    v_mfma_f32_32x32x16_bf16 v[116:131], v[56:59], v[136:139], v[116:131]
    s_waitcnt lgkmcnt(0)
    v_exp_f32 v76, v76
    v_exp_f32 v77, v77
    v_exp_f32 v78, v78
    v_exp_f32 v79, v79
    v_cvt_pk_bf16_f32 v136, v76, v77
    v_cvt_pk_bf16_f32 v137, v78, v79
    v_add_u32 v11, 0x3400, v11
    v_mfma_f32_32x32x16_bf16 v[100:115], v[60:63], v[132:135], v[100:115]
    ds_read_b128 v[52:55], v11 offset:0
    v_exp_f32 v80, v80
    v_exp_f32 v81, v81
    v_exp_f32 v82, v82
    v_exp_f32 v83, v83
    v_cvt_pk_bf16_f32 v138, v80, v81
    v_cvt_pk_bf16_f32 v139, v82, v83
    v_mfma_f32_32x32x16_bf16 v[68:83], v[28:31], v[16:19], 0
    ds_read_b128 v[56:59], v11 offset:1024
    v_exp_f32 v84, v84
    v_exp_f32 v85, v85
    v_exp_f32 v86, v86
    v_exp_f32 v87, v87
    v_cvt_pk_bf16_f32 v132, v84, v85
    v_cvt_pk_bf16_f32 v133, v86, v87
    v_mfma_f32_32x32x8_bf16 v[68:83], v[44:45], v[24:25], v[68:83]
    s_add_u32 s18, s43, 4096
    buffer_load_dwordx4 v[164:167], v7, s[8:11], s18 offen
    v_exp_f32 v88, v88
    v_exp_f32 v89, v89
    v_exp_f32 v90, v90
    v_exp_f32 v91, v91
    v_cvt_pk_bf16_f32 v134, v88, v89
    v_cvt_pk_bf16_f32 v135, v90, v91
    v_mfma_f32_32x32x16_bf16 v[100:115], v[64:67], v[136:139], v[100:115]
    s_add_u32 s18, s43, 8192
    buffer_load_dwordx4 v[168:171], v7, s[8:11], s18 offen
    v_exp_f32 v92, v92
    v_exp_f32 v93, v93
    v_exp_f32 v94, v94
    v_exp_f32 v95, v95
    v_cvt_pk_bf16_f32 v136, v92, v93
    v_cvt_pk_bf16_f32 v137, v94, v95
    v_mfma_f32_32x32x16_bf16 v[116:131], v[60:63], v[132:135], v[116:131]
    v_exp_f32 v96, v96
    v_exp_f32 v97, v97
    v_exp_f32 v98, v98
    v_exp_f32 v99, v99
    v_cvt_pk_bf16_f32 v138, v96, v97
    v_cvt_pk_bf16_f32 v139, v98, v99
    v_mfma_f32_32x32x16_bf16 v[84:99], v[28:31], v[20:23], 0
    s_add_u32 m0, s29, 0
    s_add_u32 s18, s26, 5120
    buffer_load_dwordx4 v7, s[8:11], s18 offen sc1 lds
    v_exp_f32 v68, v68
    v_exp_f32 v69, v69
    v_exp_f32 v70, v70
    v_exp_f32 v71, v71
    v_cvt_pk_bf16_f32 v132, v68, v69
    v_cvt_pk_bf16_f32 v133, v70, v71
    v_mfma_f32_32x32x8_bf16 v[84:99], v[44:45], v[26:27], v[84:99]
    s_setprio 2
    s_add_u32 m0, s32, 4096
    s_add_u32 s18, s27, 70656
    s_mov_b64 exec, s[36:37]
    buffer_load_dwordx4 v7, s[8:11], s18 offen sc1 lds
    s_mov_b64 exec, -1
    v_exp_f32 v72, v72
    v_exp_f32 v73, v73
    v_exp_f32 v74, v74
    v_exp_f32 v75, v75
    v_cvt_pk_bf16_f32 v134, v72, v73
    v_cvt_pk_bf16_f32 v135, v74, v75
    v_mfma_f32_32x32x16_bf16 v[116:131], v[64:67], v[136:139], v[116:131]
    s_waitcnt lgkmcnt(0)
    v_exp_f32 v76, v76
    v_exp_f32 v77, v77
    v_exp_f32 v78, v78
    v_exp_f32 v79, v79
    v_cvt_pk_bf16_f32 v136, v76, v77
    v_cvt_pk_bf16_f32 v137, v78, v79
    v_mfma_f32_32x32x16_bf16 v[100:115], v[52:55], v[132:135], v[100:115]
    ds_read_b128 v[60:63], v11 offset:2048
    v_exp_f32 v80, v80
    v_exp_f32 v81, v81
    v_exp_f32 v82, v82
    v_exp_f32 v83, v83
    v_cvt_pk_bf16_f32 v138, v80, v81
    v_cvt_pk_bf16_f32 v139, v82, v83
    v_mfma_f32_32x32x16_bf16 v[68:83], v[32:35], v[16:19], 0
    ds_read_b128 v[64:67], v11 offset:3072
    v_exp_f32 v84, v84
    v_exp_f32 v85, v85
    v_exp_f32 v86, v86
    v_exp_f32 v87, v87
    v_cvt_pk_bf16_f32 v132, v84, v85
    v_cvt_pk_bf16_f32 v133, v86, v87
    v_mfma_f32_32x32x8_bf16 v[68:83], v[46:47], v[24:25], v[68:83]
    ds_read2_b64 v[36:39], v9 offset0:64 offset1:192
    v_exp_f32 v88, v88
    v_exp_f32 v89, v89
    v_exp_f32 v90, v90
    v_exp_f32 v91, v91
    v_cvt_pk_bf16_f32 v134, v88, v89
    v_cvt_pk_bf16_f32 v135, v90, v91
    v_mfma_f32_32x32x16_bf16 v[100:115], v[56:59], v[136:139], v[100:115]
    ds_read2_b64 v[40:43], v9 offset0:65 offset1:193
    v_exp_f32 v92, v92
    v_exp_f32 v93, v93
    v_exp_f32 v94, v94
    v_exp_f32 v95, v95
    v_cvt_pk_bf16_f32 v136, v92, v93
    v_cvt_pk_bf16_f32 v137, v94, v95
    v_mfma_f32_32x32x16_bf16 v[116:131], v[52:55], v[132:135], v[116:131]
    ds_read_b128 v[48:51], v10 offset:512
    v_exp_f32 v96, v96
    v_exp_f32 v97, v97
    v_exp_f32 v98, v98
    v_exp_f32 v99, v99
    v_cvt_pk_bf16_f32 v138, v96, v97
    v_cvt_pk_bf16_f32 v139, v98, v99
    v_mfma_f32_32x32x16_bf16 v[84:99], v[32:35], v[20:23], 0
    s_add_u32 m0, s31, 5120
    s_add_u32 s18, s28, 6062080
    s_mov_b64 exec, s[34:35]
    buffer_load_dwordx4 v8, s[8:11], s18 offen sc1 lds
    s_add_u32 m0, m0, 1024
    s_add_u32 s18, s18, 20480
    buffer_load_dwordx4 v8, s[8:11], s18 offen sc1 lds
    s_mov_b64 exec, -1
    v_exp_f32 v68, v68
    v_exp_f32 v69, v69
    v_exp_f32 v70, v70
    v_exp_f32 v71, v71
    v_cvt_pk_bf16_f32 v132, v68, v69
    v_cvt_pk_bf16_f32 v133, v70, v71
    v_mfma_f32_32x32x8_bf16 v[84:99], v[46:47], v[26:27], v[84:99]
    s_add_u32 s18, s43, 12288
    buffer_load_dwordx4 v[172:175], v7, s[8:11], s18 offen
    v_exp_f32 v72, v72
    v_exp_f32 v73, v73
    v_exp_f32 v74, v74
    v_exp_f32 v75, v75
    v_cvt_pk_bf16_f32 v134, v72, v73
    v_cvt_pk_bf16_f32 v135, v74, v75
    v_mfma_f32_32x32x16_bf16 v[116:131], v[56:59], v[136:139], v[116:131]
    s_waitcnt lgkmcnt(0)
    v_exp_f32 v76, v76
    v_exp_f32 v77, v77
    v_exp_f32 v78, v78
    v_exp_f32 v79, v79
    v_cvt_pk_bf16_f32 v136, v76, v77
    v_cvt_pk_bf16_f32 v137, v78, v79
    v_mfma_f32_32x32x16_bf16 v[100:115], v[60:63], v[132:135], v[100:115]
    ds_read_b128 v[52:55], v11 offset:4096
    v_exp_f32 v80, v80
    v_exp_f32 v81, v81
    v_exp_f32 v82, v82
    v_exp_f32 v83, v83
    v_cvt_pk_bf16_f32 v138, v80, v81
    v_cvt_pk_bf16_f32 v139, v82, v83
    v_mfma_f32_32x32x16_bf16 v[68:83], v[36:39], v[16:19], 0
    ds_read_b128 v[56:59], v11 offset:5120
    v_exp_f32 v84, v84
    v_exp_f32 v85, v85
    v_exp_f32 v86, v86
    v_exp_f32 v87, v87
    v_cvt_pk_bf16_f32 v132, v84, v85
    v_cvt_pk_bf16_f32 v133, v86, v87
    v_mfma_f32_32x32x8_bf16 v[68:83], v[48:49], v[24:25], v[68:83]
    s_add_u32 s18, s43, 16384
    buffer_load_dwordx4 v[176:179], v7, s[8:11], s18 offen
    v_exp_f32 v88, v88
    v_exp_f32 v89, v89
    v_exp_f32 v90, v90
    v_exp_f32 v91, v91
    v_cvt_pk_bf16_f32 v134, v88, v89
    v_cvt_pk_bf16_f32 v135, v90, v91
    v_mfma_f32_32x32x16_bf16 v[100:115], v[64:67], v[136:139], v[100:115]
    s_add_u32 s18, s43, 20480
    buffer_load_dwordx4 v[180:183], v7, s[8:11], s18 offen
    v_exp_f32 v92, v92
    v_exp_f32 v93, v93
    v_exp_f32 v94, v94
    v_exp_f32 v95, v95
    v_cvt_pk_bf16_f32 v136, v92, v93
    v_cvt_pk_bf16_f32 v137, v94, v95
    v_mfma_f32_32x32x16_bf16 v[116:131], v[60:63], v[132:135], v[116:131]
    s_lshl_b32 s17, s66, 7
    s_add_u32 s17, s17, 19488768
    v_and_b32 v12, 31, v1
    v_lshlrev_b32 v12, 2, v12
    buffer_load_dword v13, v12, s[8:11], s17 offen sc1
    v_exp_f32 v96, v96
    v_exp_f32 v97, v97
    v_exp_f32 v98, v98
    v_exp_f32 v99, v99
    v_cvt_pk_bf16_f32 v138, v96, v97
    v_cvt_pk_bf16_f32 v139, v98, v99
    v_mfma_f32_32x32x16_bf16 v[84:99], v[36:39], v[20:23], 0
    s_add_u32 s18, s43, 24576
    buffer_load_dwordx4 v[184:187], v7, s[8:11], s18 offen
    v_exp_f32 v68, v68
    v_exp_f32 v69, v69
    v_exp_f32 v70, v70
    v_exp_f32 v71, v71
    v_cvt_pk_bf16_f32 v132, v68, v69
    v_cvt_pk_bf16_f32 v133, v70, v71
    v_mfma_f32_32x32x8_bf16 v[84:99], v[48:49], v[26:27], v[84:99]
    s_setprio 1
    s_add_u32 s18, s43, 28672
    buffer_load_dwordx4 v[188:191], v7, s[8:11], s18 offen
    v_exp_f32 v72, v72
    v_exp_f32 v73, v73
    v_exp_f32 v74, v74
    v_exp_f32 v75, v75
    v_cvt_pk_bf16_f32 v134, v72, v73
    v_cvt_pk_bf16_f32 v135, v74, v75
    v_mfma_f32_32x32x16_bf16 v[116:131], v[64:67], v[136:139], v[116:131]
    s_waitcnt lgkmcnt(0)
    v_exp_f32 v76, v76
    v_exp_f32 v77, v77
    v_exp_f32 v78, v78
    v_exp_f32 v79, v79
    v_cvt_pk_bf16_f32 v136, v76, v77
    v_cvt_pk_bf16_f32 v137, v78, v79
    v_mfma_f32_32x32x16_bf16 v[100:115], v[52:55], v[132:135], v[100:115]
    ds_read_b128 v[60:63], v11 offset:6144
    v_exp_f32 v80, v80
    v_exp_f32 v81, v81
    v_exp_f32 v82, v82
    v_exp_f32 v83, v83
    v_cvt_pk_bf16_f32 v138, v80, v81
    v_cvt_pk_bf16_f32 v139, v82, v83
    v_mfma_f32_32x32x16_bf16 v[68:83], v[40:43], v[16:19], 0
    ds_read_b128 v[64:67], v11 offset:7168
    v_exp_f32 v84, v84
    v_exp_f32 v85, v85
    v_exp_f32 v86, v86
    v_exp_f32 v87, v87
    v_cvt_pk_bf16_f32 v132, v84, v85
    v_cvt_pk_bf16_f32 v133, v86, v87
    v_add_u32 v9, 0x3400, v9
    v_add_u32 v10, 0x3400, v10
    v_mfma_f32_32x32x8_bf16 v[68:83], v[50:51], v[24:25], v[68:83]
    ds_read2_b64 v[28:31], v9 offset0:0 offset1:128
    v_exp_f32 v88, v88
    v_exp_f32 v89, v89
    v_exp_f32 v90, v90
    v_exp_f32 v91, v91
    v_cvt_pk_bf16_f32 v134, v88, v89
    v_cvt_pk_bf16_f32 v135, v90, v91
    v_mfma_f32_32x32x16_bf16 v[100:115], v[56:59], v[136:139], v[100:115]
    ds_read2_b64 v[32:35], v9 offset0:1 offset1:129
    v_exp_f32 v92, v92
    v_exp_f32 v93, v93
    v_exp_f32 v94, v94
    v_exp_f32 v95, v95
    v_cvt_pk_bf16_f32 v136, v92, v93
    v_cvt_pk_bf16_f32 v137, v94, v95
    v_mfma_f32_32x32x16_bf16 v[116:131], v[52:55], v[132:135], v[116:131]
    ds_read_b128 v[44:47], v10 offset:0
    v_exp_f32 v96, v96
    v_exp_f32 v97, v97
    v_exp_f32 v98, v98
    v_exp_f32 v99, v99
    v_cvt_pk_bf16_f32 v138, v96, v97
    v_cvt_pk_bf16_f32 v139, v98, v99
    v_mfma_f32_32x32x16_bf16 v[84:99], v[40:43], v[20:23], 0
    s_add_u32 s18, s43, 32768
    buffer_load_dwordx4 v[192:195], v7, s[8:11], s18 offen
    v_exp_f32 v68, v68
    v_exp_f32 v69, v69
    v_exp_f32 v70, v70
    v_exp_f32 v71, v71
    v_cvt_pk_bf16_f32 v132, v68, v69
    v_cvt_pk_bf16_f32 v133, v70, v71
    v_mfma_f32_32x32x8_bf16 v[84:99], v[50:51], v[26:27], v[84:99]
    s_add_u32 s18, s43, 36864
    buffer_load_dwordx4 v[196:199], v7, s[8:11], s18 offen
    v_exp_f32 v72, v72
    v_exp_f32 v73, v73
    v_exp_f32 v74, v74
    v_exp_f32 v75, v75
    v_cvt_pk_bf16_f32 v134, v72, v73
    v_cvt_pk_bf16_f32 v135, v74, v75
    v_mfma_f32_32x32x16_bf16 v[116:131], v[56:59], v[136:139], v[116:131]
    s_waitcnt lgkmcnt(0)
    v_exp_f32 v76, v76
    v_exp_f32 v77, v77
    v_exp_f32 v78, v78
    v_exp_f32 v79, v79
    v_cvt_pk_bf16_f32 v136, v76, v77
    v_cvt_pk_bf16_f32 v137, v78, v79
    v_add_u32 v11, 0x3400, v11
    v_mfma_f32_32x32x16_bf16 v[100:115], v[60:63], v[132:135], v[100:115]
    ds_read_b128 v[52:55], v11 offset:0
    v_exp_f32 v80, v80
    v_exp_f32 v81, v81
    v_exp_f32 v82, v82
    v_exp_f32 v83, v83
    v_cvt_pk_bf16_f32 v138, v80, v81
    v_cvt_pk_bf16_f32 v139, v82, v83
    v_mfma_f32_32x32x16_bf16 v[68:83], v[28:31], v[16:19], 0
    ds_read_b128 v[56:59], v11 offset:1024
    v_exp_f32 v84, v84
    v_exp_f32 v85, v85
    v_exp_f32 v86, v86
    v_exp_f32 v87, v87
    v_cvt_pk_bf16_f32 v132, v84, v85
    v_cvt_pk_bf16_f32 v133, v86, v87
    v_mfma_f32_32x32x8_bf16 v[68:83], v[44:45], v[24:25], v[68:83]
    s_add_u32 s69, s60, s68
    s_bfe_u32 s60, s67, 0x10002
    v_exp_f32 v88, v88
    v_exp_f32 v89, v89
    v_exp_f32 v90, v90
    v_exp_f32 v91, v91
    v_cvt_pk_bf16_f32 v134, v88, v89
    v_cvt_pk_bf16_f32 v135, v90, v91
    v_mfma_f32_32x32x16_bf16 v[100:115], v[64:67], v[136:139], v[100:115]
    s_lshl_b32 s60, s60, 9
    s_add_u32 s68, s68, s60
    v_exp_f32 v92, v92
    v_exp_f32 v93, v93
    v_exp_f32 v94, v94
    v_exp_f32 v95, v95
    v_cvt_pk_bf16_f32 v136, v92, v93
    v_cvt_pk_bf16_f32 v137, v94, v95
    v_mfma_f32_32x32x16_bf16 v[116:131], v[60:63], v[132:135], v[116:131]
    s_and_b32 s60, s67, 1
    s_lshl_b32 s60, s60, 8
    v_exp_f32 v96, v96
    v_exp_f32 v97, v97
    v_exp_f32 v98, v98
    v_exp_f32 v99, v99
    v_cvt_pk_bf16_f32 v138, v96, v97
    v_cvt_pk_bf16_f32 v139, v98, v99
    v_mfma_f32_32x32x16_bf16 v[84:99], v[28:31], v[20:23], 0
    s_add_u32 s18, s43, 40960
    buffer_load_dwordx4 v[200:203], v7, s[8:11], s18 offen
    v_exp_f32 v68, v68
    v_exp_f32 v69, v69
    v_exp_f32 v70, v70
    v_exp_f32 v71, v71
    v_cvt_pk_bf16_f32 v132, v68, v69
    v_cvt_pk_bf16_f32 v133, v70, v71
    v_mfma_f32_32x32x8_bf16 v[84:99], v[44:45], v[26:27], v[84:99]
    s_setprio 0
    s_add_u32 s18, s43, 45056
    buffer_load_dwordx4 v[204:207], v7, s[8:11], s18 offen
    v_exp_f32 v72, v72
    v_exp_f32 v73, v73
    v_exp_f32 v74, v74
    v_exp_f32 v75, v75
    v_cvt_pk_bf16_f32 v134, v72, v73
    v_cvt_pk_bf16_f32 v135, v74, v75
    v_mfma_f32_32x32x16_bf16 v[116:131], v[64:67], v[136:139], v[116:131]
    s_waitcnt lgkmcnt(0)
    v_exp_f32 v76, v76
    v_exp_f32 v77, v77
    v_exp_f32 v78, v78
    v_exp_f32 v79, v79
    v_cvt_pk_bf16_f32 v136, v76, v77
    v_cvt_pk_bf16_f32 v137, v78, v79
    v_mfma_f32_32x32x16_bf16 v[100:115], v[52:55], v[132:135], v[100:115]
    ds_read_b128 v[60:63], v11 offset:2048
    v_exp_f32 v80, v80
    v_exp_f32 v81, v81
    v_exp_f32 v82, v82
    v_exp_f32 v83, v83
    v_cvt_pk_bf16_f32 v138, v80, v81
    v_cvt_pk_bf16_f32 v139, v82, v83
    v_mfma_f32_32x32x16_bf16 v[68:83], v[32:35], v[16:19], 0
    ds_read_b128 v[64:67], v11 offset:3072
    v_exp_f32 v84, v84
    v_exp_f32 v85, v85
    v_exp_f32 v86, v86
    v_exp_f32 v87, v87
    v_cvt_pk_bf16_f32 v132, v84, v85
    v_cvt_pk_bf16_f32 v133, v86, v87
    v_mfma_f32_32x32x8_bf16 v[68:83], v[46:47], v[24:25], v[68:83]
    ds_read2_b64 v[36:39], v9 offset0:64 offset1:192
    v_exp_f32 v88, v88
    v_exp_f32 v89, v89
    v_exp_f32 v90, v90
    v_exp_f32 v91, v91
    v_cvt_pk_bf16_f32 v134, v88, v89
    v_cvt_pk_bf16_f32 v135, v90, v91
    v_mfma_f32_32x32x16_bf16 v[100:115], v[56:59], v[136:139], v[100:115]
    ds_read2_b64 v[40:43], v9 offset0:65 offset1:193
    v_exp_f32 v92, v92
    v_exp_f32 v93, v93
    v_exp_f32 v94, v94
    v_exp_f32 v95, v95
    v_cvt_pk_bf16_f32 v136, v92, v93
    v_cvt_pk_bf16_f32 v137, v94, v95
    v_mfma_f32_32x32x16_bf16 v[116:131], v[52:55], v[132:135], v[116:131]
    ds_read_b128 v[48:51], v10 offset:512
    v_exp_f32 v96, v96
    v_exp_f32 v97, v97
    v_exp_f32 v98, v98
    v_exp_f32 v99, v99
    v_cvt_pk_bf16_f32 v138, v96, v97
    v_cvt_pk_bf16_f32 v139, v98, v99
    v_mfma_f32_32x32x16_bf16 v[84:99], v[32:35], v[20:23], 0
    s_add_u32 s18, s33, 0
    buffer_load_dwordx4 v[208:211], v7, s[8:11], s18 offen
    v_exp_f32 v68, v68
    v_exp_f32 v69, v69
    v_exp_f32 v70, v70
    v_exp_f32 v71, v71
    v_cvt_pk_bf16_f32 v132, v68, v69
    v_cvt_pk_bf16_f32 v133, v70, v71
    v_mfma_f32_32x32x8_bf16 v[84:99], v[46:47], v[26:27], v[84:99]
    s_add_u32 s18, s33, 4096
    buffer_load_dwordx4 v[212:215], v7, s[8:11], s18 offen
    v_exp_f32 v72, v72
    v_exp_f32 v73, v73
    v_exp_f32 v74, v74
    v_exp_f32 v75, v75
    v_cvt_pk_bf16_f32 v134, v72, v73
    v_cvt_pk_bf16_f32 v135, v74, v75
    v_mfma_f32_32x32x16_bf16 v[116:131], v[56:59], v[136:139], v[116:131]
    s_waitcnt lgkmcnt(0)
    v_exp_f32 v76, v76
    v_exp_f32 v77, v77
    v_exp_f32 v78, v78
    v_exp_f32 v79, v79
    v_cvt_pk_bf16_f32 v136, v76, v77
    v_cvt_pk_bf16_f32 v137, v78, v79
    v_mfma_f32_32x32x16_bf16 v[100:115], v[60:63], v[132:135], v[100:115]
    ds_read_b128 v[52:55], v11 offset:4096
    v_exp_f32 v80, v80
    v_exp_f32 v81, v81
    v_exp_f32 v82, v82
    v_exp_f32 v83, v83
    v_cvt_pk_bf16_f32 v138, v80, v81
    v_cvt_pk_bf16_f32 v139, v82, v83
    v_mfma_f32_32x32x16_bf16 v[68:83], v[36:39], v[16:19], 0
    ds_read_b128 v[56:59], v11 offset:5120
    v_exp_f32 v84, v84
    v_exp_f32 v85, v85
    v_exp_f32 v86, v86
    v_exp_f32 v87, v87
    v_cvt_pk_bf16_f32 v132, v84, v85
    v_cvt_pk_bf16_f32 v133, v86, v87
    v_mfma_f32_32x32x8_bf16 v[68:83], v[48:49], v[24:25], v[68:83]
    s_add_u32 s68, s68, s60
    s_bfe_u32 s60, s67, 0x10001
    v_exp_f32 v88, v88
    v_exp_f32 v89, v89
    v_exp_f32 v90, v90
    v_exp_f32 v91, v91
    v_cvt_pk_bf16_f32 v134, v88, v89
    v_cvt_pk_bf16_f32 v135, v90, v91
    v_mfma_f32_32x32x16_bf16 v[100:115], v[64:67], v[136:139], v[100:115]
    s_lshl3_add_u32 s68, s60, s68
    s_add_u32 s68, s68, 4096
    v_exp_f32 v92, v92
    v_exp_f32 v93, v93
    v_exp_f32 v94, v94
    v_exp_f32 v95, v95
    v_cvt_pk_bf16_f32 v136, v92, v93
    v_cvt_pk_bf16_f32 v137, v94, v95
    v_mfma_f32_32x32x16_bf16 v[116:131], v[60:63], v[132:135], v[116:131]
    s_waitcnt vmcnt(8)
    s_barrier
    v_cmp_ne_u32 vcc, s65, v13
    s_nop 0
    s_cmp_eq_u64 vcc, 0
    s_cselect_b32 s6, 0x2000000, 0
    s_cmp_eq_u32 s14, 0
    s_cbranch_scc1 F_rz
    s_add_u32 s18, s3, 0x1611000
    buffer_load_dwordx4 v[140:143], v7, s[8:11], s18 offen
    s_add_u32 s18, s3, 0x1612000
    buffer_load_dwordx4 v[144:147], v7, s[8:11], s18 offen
    s_add_u32 s18, s3, 0x1613000
    buffer_load_dwordx4 v[148:151], v7, s[8:11], s18 offen
    s_add_u32 s18, s3, 0x162f000
    buffer_load_dwordx4 v[152:155], v7, s[8:11], s18 offen
    s_add_u32 s18, s3, 0x1630000
    buffer_load_dwordx4 v[156:159], v7, s[8:11], s18 offen
F_rz:
    v_exp_f32 v96, v96
    v_exp_f32 v97, v97
    v_exp_f32 v98, v98
    v_exp_f32 v99, v99
    v_cvt_pk_bf16_f32 v138, v96, v97
    v_cvt_pk_bf16_f32 v139, v98, v99
    v_mfma_f32_32x32x16_bf16 v[84:99], v[36:39], v[20:23], 0
    s_add_u32 m0, s29, 13312
    s_add_u32 s18, s26, 6144
    buffer_load_dwordx4 v7, s[8:11], s18 offen sc1 lds
    v_exp_f32 v68, v68
    v_exp_f32 v69, v69
    v_exp_f32 v70, v70
    v_exp_f32 v71, v71
    v_cvt_pk_bf16_f32 v132, v68, v69
    v_cvt_pk_bf16_f32 v133, v70, v71
    v_mfma_f32_32x32x8_bf16 v[84:99], v[48:49], v[26:27], v[84:99]
    s_setprio 3
    s_add_u32 m0, s32, 17408
    s_add_u32 s18, s27, 71680
    s_mov_b64 exec, s[36:37]
    buffer_load_dwordx4 v7, s[8:11], s18 offen sc1 lds
    s_mov_b64 exec, -1
    v_exp_f32 v72, v72
    v_exp_f32 v73, v73
    v_exp_f32 v74, v74
    v_exp_f32 v75, v75
    v_cvt_pk_bf16_f32 v134, v72, v73
    v_cvt_pk_bf16_f32 v135, v74, v75
    v_mfma_f32_32x32x16_bf16 v[116:131], v[64:67], v[136:139], v[116:131]
    s_waitcnt lgkmcnt(0)
    v_exp_f32 v76, v76
    v_exp_f32 v77, v77
    v_exp_f32 v78, v78
    v_exp_f32 v79, v79
    v_cvt_pk_bf16_f32 v136, v76, v77
    v_cvt_pk_bf16_f32 v137, v78, v79
    v_mfma_f32_32x32x16_bf16 v[100:115], v[52:55], v[132:135], v[100:115]
    ds_read_b128 v[60:63], v11 offset:6144
    v_exp_f32 v80, v80
    v_exp_f32 v81, v81
    v_exp_f32 v82, v82
    v_exp_f32 v83, v83
    v_cvt_pk_bf16_f32 v138, v80, v81
    v_cvt_pk_bf16_f32 v139, v82, v83
    v_mfma_f32_32x32x16_bf16 v[68:83], v[40:43], v[16:19], 0
    ds_read_b128 v[64:67], v11 offset:7168
    v_exp_f32 v84, v84
    v_exp_f32 v85, v85
    v_exp_f32 v86, v86
    v_exp_f32 v87, v87
    v_cvt_pk_bf16_f32 v132, v84, v85
    v_cvt_pk_bf16_f32 v133, v86, v87
    v_add_u32 v9, 0x3400, v9
    v_add_u32 v10, 0x3400, v10
    v_mfma_f32_32x32x8_bf16 v[68:83], v[50:51], v[24:25], v[68:83]
    ds_read2_b64 v[28:31], v9 offset0:0 offset1:128
    v_exp_f32 v88, v88
    v_exp_f32 v89, v89
    v_exp_f32 v90, v90
    v_exp_f32 v91, v91
    v_cvt_pk_bf16_f32 v134, v88, v89
    v_cvt_pk_bf16_f32 v135, v90, v91
    v_mfma_f32_32x32x16_bf16 v[100:115], v[56:59], v[136:139], v[100:115]
    ds_read2_b64 v[32:35], v9 offset0:1 offset1:129
    v_exp_f32 v92, v92
    v_exp_f32 v93, v93
    v_exp_f32 v94, v94
    v_exp_f32 v95, v95
    v_cvt_pk_bf16_f32 v136, v92, v93
    v_cvt_pk_bf16_f32 v137, v94, v95
    v_mfma_f32_32x32x16_bf16 v[116:131], v[52:55], v[132:135], v[116:131]
    ds_read_b128 v[44:47], v10 offset:0
    v_exp_f32 v96, v96
    v_exp_f32 v97, v97
    v_exp_f32 v98, v98
    v_exp_f32 v99, v99
    v_cvt_pk_bf16_f32 v138, v96, v97
    v_cvt_pk_bf16_f32 v139, v98, v99
    v_mfma_f32_32x32x16_bf16 v[84:99], v[40:43], v[20:23], 0
    s_add_u32 m0, s31, 18432
    s_add_u32 s18, s28, 6225920
    s_mov_b64 exec, s[34:35]
    buffer_load_dwordx4 v8, s[8:11], s18 offen sc1 lds
    s_add_u32 m0, m0, 1024
    s_add_u32 s18, s18, 20480
    buffer_load_dwordx4 v8, s[8:11], s18 offen sc1 lds
    s_mov_b64 exec, -1
    v_exp_f32 v68, v68
    v_exp_f32 v69, v69
    v_exp_f32 v70, v70
    v_exp_f32 v71, v71
    v_cvt_pk_bf16_f32 v132, v68, v69
    v_cvt_pk_bf16_f32 v133, v70, v71
    v_mfma_f32_32x32x8_bf16 v[84:99], v[50:51], v[26:27], v[84:99]
    s_getpc_b64 s[60:61]
F_pc:
    s_lshl3_add_u32 s17, s67, s12
    s_lshl_b32 s17, s17, 7
    s_min_u32 s17, s17, code_end-F_pc-4
    v_mov_b32 v4, s17
    s_mov_b64 exec, 1
    global_load_dword v5, v4, s[60:61]
    s_mov_b64 exec, -1
    v_exp_f32 v72, v72
    v_exp_f32 v73, v73
    v_exp_f32 v74, v74
    v_exp_f32 v75, v75
    v_cvt_pk_bf16_f32 v134, v72, v73
    v_cvt_pk_bf16_f32 v135, v74, v75
    v_mfma_f32_32x32x16_bf16 v[116:131], v[56:59], v[136:139], v[116:131]
    s_waitcnt lgkmcnt(0)
    v_exp_f32 v76, v76
    v_exp_f32 v77, v77
    v_exp_f32 v78, v78
    v_exp_f32 v79, v79
    v_cvt_pk_bf16_f32 v136, v76, v77
    v_cvt_pk_bf16_f32 v137, v78, v79
    v_add_u32 v11, 0x3400, v11
    v_mfma_f32_32x32x16_bf16 v[100:115], v[60:63], v[132:135], v[100:115]
    ds_read_b128 v[52:55], v11 offset:0
    v_exp_f32 v80, v80
    v_exp_f32 v81, v81
    v_exp_f32 v82, v82
    v_exp_f32 v83, v83
    v_cvt_pk_bf16_f32 v138, v80, v81
    v_cvt_pk_bf16_f32 v139, v82, v83
    v_mfma_f32_32x32x16_bf16 v[68:83], v[28:31], v[16:19], 0
    ds_read_b128 v[56:59], v11 offset:1024
    v_exp_f32 v84, v84
    v_exp_f32 v85, v85
    v_exp_f32 v86, v86
    v_exp_f32 v87, v87
    v_cvt_pk_bf16_f32 v132, v84, v85
    v_cvt_pk_bf16_f32 v133, v86, v87
    v_mfma_f32_32x32x8_bf16 v[68:83], v[44:45], v[24:25], v[68:83]
    v_exp_f32 v88, v88
    v_exp_f32 v89, v89
    v_exp_f32 v90, v90
    v_exp_f32 v91, v91
    v_cvt_pk_bf16_f32 v134, v88, v89
    v_cvt_pk_bf16_f32 v135, v90, v91
    v_mfma_f32_32x32x16_bf16 v[100:115], v[64:67], v[136:139], v[100:115]
    v_exp_f32 v92, v92
    v_exp_f32 v93, v93
    v_exp_f32 v94, v94
    v_exp_f32 v95, v95
    v_cvt_pk_bf16_f32 v136, v92, v93
    v_cvt_pk_bf16_f32 v137, v94, v95
    v_mfma_f32_32x32x16_bf16 v[116:131], v[60:63], v[132:135], v[116:131]
    v_exp_f32 v96, v96
    v_exp_f32 v97, v97
    v_exp_f32 v98, v98
    v_exp_f32 v99, v99
    v_cvt_pk_bf16_f32 v138, v96, v97
    v_cvt_pk_bf16_f32 v139, v98, v99
    v_mfma_f32_32x32x16_bf16 v[84:99], v[28:31], v[20:23], 0
    s_add_u32 s18, s33, 8192
    buffer_load_dwordx4 v[216:219], v7, s[8:11], s18 offen
    v_exp_f32 v68, v68
    v_exp_f32 v69, v69
    v_exp_f32 v70, v70
    v_exp_f32 v71, v71
    v_cvt_pk_bf16_f32 v132, v68, v69
    v_cvt_pk_bf16_f32 v133, v70, v71
    v_mfma_f32_32x32x8_bf16 v[84:99], v[44:45], v[26:27], v[84:99]
    s_setprio 2
    s_add_u32 s18, s33, 12288
    buffer_load_dwordx4 v[220:223], v7, s[8:11], s18 offen
    v_exp_f32 v72, v72
    v_exp_f32 v73, v73
    v_exp_f32 v74, v74
    v_exp_f32 v75, v75
    v_cvt_pk_bf16_f32 v134, v72, v73
    v_cvt_pk_bf16_f32 v135, v74, v75
    v_mfma_f32_32x32x16_bf16 v[116:131], v[64:67], v[136:139], v[116:131]
    s_waitcnt lgkmcnt(0)
    v_exp_f32 v76, v76
    v_exp_f32 v77, v77
    v_exp_f32 v78, v78
    v_exp_f32 v79, v79
    v_cvt_pk_bf16_f32 v136, v76, v77
    v_cvt_pk_bf16_f32 v137, v78, v79
    v_mfma_f32_32x32x16_bf16 v[100:115], v[52:55], v[132:135], v[100:115]
    ds_read_b128 v[60:63], v11 offset:2048
    v_exp_f32 v80, v80
    v_exp_f32 v81, v81
    v_exp_f32 v82, v82
    v_exp_f32 v83, v83
    v_cvt_pk_bf16_f32 v138, v80, v81
    v_cvt_pk_bf16_f32 v139, v82, v83
    v_mfma_f32_32x32x16_bf16 v[68:83], v[32:35], v[16:19], 0
    ds_read_b128 v[64:67], v11 offset:3072
    v_exp_f32 v84, v84
    v_exp_f32 v85, v85
    v_exp_f32 v86, v86
    v_exp_f32 v87, v87
    v_cvt_pk_bf16_f32 v132, v84, v85
    v_cvt_pk_bf16_f32 v133, v86, v87
    v_mfma_f32_32x32x8_bf16 v[68:83], v[46:47], v[24:25], v[68:83]
    ds_read2_b64 v[36:39], v9 offset0:64 offset1:192
    v_exp_f32 v88, v88
    v_exp_f32 v89, v89
    v_exp_f32 v90, v90
    v_exp_f32 v91, v91
    v_cvt_pk_bf16_f32 v134, v88, v89
    v_cvt_pk_bf16_f32 v135, v90, v91
    v_mfma_f32_32x32x16_bf16 v[100:115], v[56:59], v[136:139], v[100:115]
    ds_read2_b64 v[40:43], v9 offset0:65 offset1:193
    v_exp_f32 v92, v92
    v_exp_f32 v93, v93
    v_exp_f32 v94, v94
    v_exp_f32 v95, v95
    v_cvt_pk_bf16_f32 v136, v92, v93
    v_cvt_pk_bf16_f32 v137, v94, v95
    v_mfma_f32_32x32x16_bf16 v[116:131], v[52:55], v[132:135], v[116:131]
    ds_read_b128 v[48:51], v10 offset:512
    v_exp_f32 v96, v96
    v_exp_f32 v97, v97
    v_exp_f32 v98, v98
    v_exp_f32 v99, v99
    v_cvt_pk_bf16_f32 v138, v96, v97
    v_cvt_pk_bf16_f32 v139, v98, v99
    v_mfma_f32_32x32x16_bf16 v[84:99], v[32:35], v[20:23], 0
    s_add_u32 s18, s33, 16384
    buffer_load_dwordx4 v[224:227], v7, s[8:11], s18 offen
    v_exp_f32 v68, v68
    v_exp_f32 v69, v69
    v_exp_f32 v70, v70
    v_exp_f32 v71, v71
    v_cvt_pk_bf16_f32 v132, v68, v69
    v_cvt_pk_bf16_f32 v133, v70, v71
    v_mfma_f32_32x32x8_bf16 v[84:99], v[46:47], v[26:27], v[84:99]
    s_add_u32 s18, s33, 20480
    buffer_load_dwordx4 v[228:231], v7, s[8:11], s18 offen
    v_exp_f32 v72, v72
    v_exp_f32 v73, v73
    v_exp_f32 v74, v74
    v_exp_f32 v75, v75
    v_cvt_pk_bf16_f32 v134, v72, v73
    v_cvt_pk_bf16_f32 v135, v74, v75
    v_mfma_f32_32x32x16_bf16 v[116:131], v[56:59], v[136:139], v[116:131]
    s_waitcnt lgkmcnt(0)
    v_exp_f32 v76, v76
    v_exp_f32 v77, v77
    v_exp_f32 v78, v78
    v_exp_f32 v79, v79
    v_cvt_pk_bf16_f32 v136, v76, v77
    v_cvt_pk_bf16_f32 v137, v78, v79
    v_mfma_f32_32x32x16_bf16 v[100:115], v[60:63], v[132:135], v[100:115]
    ds_read_b128 v[52:55], v11 offset:4096
    v_exp_f32 v80, v80
    v_exp_f32 v81, v81
    v_exp_f32 v82, v82
    v_exp_f32 v83, v83
    v_cvt_pk_bf16_f32 v138, v80, v81
    v_cvt_pk_bf16_f32 v139, v82, v83
    v_mfma_f32_32x32x16_bf16 v[68:83], v[36:39], v[16:19], 0
    ds_read_b128 v[56:59], v11 offset:5120
    v_exp_f32 v84, v84
    v_exp_f32 v85, v85
    v_exp_f32 v86, v86
    v_exp_f32 v87, v87
    v_cvt_pk_bf16_f32 v132, v84, v85
    v_cvt_pk_bf16_f32 v133, v86, v87
    v_mfma_f32_32x32x8_bf16 v[68:83], v[48:49], v[24:25], v[68:83]
    s_add_u32 s18, s33, 24576
    buffer_load_dwordx4 v[232:235], v7, s[8:11], s18 offen
    v_exp_f32 v88, v88
    v_exp_f32 v89, v89
    v_exp_f32 v90, v90
    v_exp_f32 v91, v91
    v_cvt_pk_bf16_f32 v134, v88, v89
    v_cvt_pk_bf16_f32 v135, v90, v91
    v_mfma_f32_32x32x16_bf16 v[100:115], v[64:67], v[136:139], v[100:115]
    v_exp_f32 v92, v92
    v_exp_f32 v93, v93
    v_exp_f32 v94, v94
    v_exp_f32 v95, v95
    v_cvt_pk_bf16_f32 v136, v92, v93
    v_cvt_pk_bf16_f32 v137, v94, v95
    v_mfma_f32_32x32x16_bf16 v[116:131], v[60:63], v[132:135], v[116:131]
    v_exp_f32 v96, v96
    v_exp_f32 v97, v97
    v_exp_f32 v98, v98
    v_exp_f32 v99, v99
    v_cvt_pk_bf16_f32 v138, v96, v97
    v_cvt_pk_bf16_f32 v139, v98, v99
    v_mfma_f32_32x32x16_bf16 v[84:99], v[36:39], v[20:23], 0
    s_add_u32 s18, s33, 28672
    buffer_load_dwordx4 v[236:239], v7, s[8:11], s18 offen
    v_exp_f32 v68, v68
    v_exp_f32 v69, v69
    v_exp_f32 v70, v70
    v_exp_f32 v71, v71
    v_cvt_pk_bf16_f32 v132, v68, v69
    v_cvt_pk_bf16_f32 v133, v70, v71
    v_mfma_f32_32x32x8_bf16 v[84:99], v[48:49], v[26:27], v[84:99]
    s_setprio 1
    s_add_u32 s18, s33, 32768
    buffer_load_dwordx4 v[240:243], v7, s[8:11], s18 offen
    v_exp_f32 v72, v72
    v_exp_f32 v73, v73
    v_exp_f32 v74, v74
    v_exp_f32 v75, v75
    v_cvt_pk_bf16_f32 v134, v72, v73
    v_cvt_pk_bf16_f32 v135, v74, v75
    v_mfma_f32_32x32x16_bf16 v[116:131], v[64:67], v[136:139], v[116:131]
    s_waitcnt lgkmcnt(0)
    v_exp_f32 v76, v76
    v_exp_f32 v77, v77
    v_exp_f32 v78, v78
    v_exp_f32 v79, v79
    v_cvt_pk_bf16_f32 v136, v76, v77
    v_cvt_pk_bf16_f32 v137, v78, v79
    v_mfma_f32_32x32x16_bf16 v[100:115], v[52:55], v[132:135], v[100:115]
    ds_read_b128 v[60:63], v11 offset:6144
    v_exp_f32 v80, v80
    v_exp_f32 v81, v81
    v_exp_f32 v82, v82
    v_exp_f32 v83, v83
    v_cvt_pk_bf16_f32 v138, v80, v81
    v_cvt_pk_bf16_f32 v139, v82, v83
    v_mfma_f32_32x32x16_bf16 v[68:83], v[40:43], v[16:19], 0
    ds_read_b128 v[64:67], v11 offset:7168
    v_exp_f32 v84, v84
    v_exp_f32 v85, v85
    v_exp_f32 v86, v86
    v_exp_f32 v87, v87
    v_cvt_pk_bf16_f32 v132, v84, v85
    v_cvt_pk_bf16_f32 v133, v86, v87
    v_add_u32 v9, 0xfffefc00, v9
    v_add_u32 v10, 0xfffefc00, v10
    v_mfma_f32_32x32x8_bf16 v[68:83], v[50:51], v[24:25], v[68:83]
    ds_read2_b64 v[28:31], v9 offset0:0 offset1:128
    v_exp_f32 v88, v88
    v_exp_f32 v89, v89
    v_exp_f32 v90, v90
    v_exp_f32 v91, v91
    v_cvt_pk_bf16_f32 v134, v88, v89
    v_cvt_pk_bf16_f32 v135, v90, v91
    v_mfma_f32_32x32x16_bf16 v[100:115], v[56:59], v[136:139], v[100:115]
    ds_read2_b64 v[32:35], v9 offset0:1 offset1:129
    v_exp_f32 v92, v92
    v_exp_f32 v93, v93
    v_exp_f32 v94, v94
    v_exp_f32 v95, v95
    v_cvt_pk_bf16_f32 v136, v92, v93
    v_cvt_pk_bf16_f32 v137, v94, v95
    v_mfma_f32_32x32x16_bf16 v[116:131], v[52:55], v[132:135], v[116:131]
    ds_read_b128 v[44:47], v10 offset:0
    v_exp_f32 v96, v96
    v_exp_f32 v97, v97
    v_exp_f32 v98, v98
    v_exp_f32 v99, v99
    v_cvt_pk_bf16_f32 v138, v96, v97
    v_cvt_pk_bf16_f32 v139, v98, v99
    v_mfma_f32_32x32x16_bf16 v[84:99], v[40:43], v[20:23], 0
    s_add_u32 s18, s33, 36864
    buffer_load_dwordx4 v[244:247], v7, s[8:11], s18 offen
    v_exp_f32 v68, v68
    v_exp_f32 v69, v69
    v_exp_f32 v70, v70
    v_exp_f32 v71, v71
    v_cvt_pk_bf16_f32 v132, v68, v69
    v_cvt_pk_bf16_f32 v133, v70, v71
    v_mfma_f32_32x32x8_bf16 v[84:99], v[50:51], v[26:27], v[84:99]
    s_add_u32 s18, s33, 40960
    buffer_load_dwordx4 v[248:251], v7, s[8:11], s18 offen
    v_exp_f32 v72, v72
    v_exp_f32 v73, v73
    v_exp_f32 v74, v74
    v_exp_f32 v75, v75
    v_cvt_pk_bf16_f32 v134, v72, v73
    v_cvt_pk_bf16_f32 v135, v74, v75
    v_mfma_f32_32x32x16_bf16 v[116:131], v[56:59], v[136:139], v[116:131]
    s_waitcnt lgkmcnt(0)
    v_exp_f32 v76, v76
    v_exp_f32 v77, v77
    v_exp_f32 v78, v78
    v_exp_f32 v79, v79
    v_cvt_pk_bf16_f32 v136, v76, v77
    v_cvt_pk_bf16_f32 v137, v78, v79
    v_add_u32 v11, 0xfffefc00, v11
    v_mfma_f32_32x32x16_bf16 v[100:115], v[60:63], v[132:135], v[100:115]
    ds_read_b128 v[52:55], v11 offset:0
    v_exp_f32 v80, v80
    v_exp_f32 v81, v81
    v_exp_f32 v82, v82
    v_exp_f32 v83, v83
    v_cvt_pk_bf16_f32 v138, v80, v81
    v_cvt_pk_bf16_f32 v139, v82, v83
    v_mfma_f32_32x32x16_bf16 v[68:83], v[28:31], v[16:19], 0
    ds_read_b128 v[56:59], v11 offset:1024
    v_exp_f32 v84, v84
    v_exp_f32 v85, v85
    v_exp_f32 v86, v86
    v_exp_f32 v87, v87
    v_cvt_pk_bf16_f32 v132, v84, v85
    v_cvt_pk_bf16_f32 v133, v86, v87
    v_mfma_f32_32x32x8_bf16 v[68:83], v[44:45], v[24:25], v[68:83]
    s_add_u32 s18, s33, 45056
    buffer_load_dwordx4 v[252:255], v7, s[8:11], s18 offen
    v_exp_f32 v88, v88
    v_exp_f32 v89, v89
    v_exp_f32 v90, v90
    v_exp_f32 v91, v91
    v_cvt_pk_bf16_f32 v134, v88, v89
    v_cvt_pk_bf16_f32 v135, v90, v91
    v_mfma_f32_32x32x16_bf16 v[100:115], v[64:67], v[136:139], v[100:115]
    v_exp_f32 v92, v92
    v_exp_f32 v93, v93
    v_exp_f32 v94, v94
    v_exp_f32 v95, v95
    v_cvt_pk_bf16_f32 v136, v92, v93
    v_cvt_pk_bf16_f32 v137, v94, v95
    v_mfma_f32_32x32x16_bf16 v[116:131], v[60:63], v[132:135], v[116:131]
    v_exp_f32 v96, v96
    v_exp_f32 v97, v97
    v_exp_f32 v98, v98
    v_exp_f32 v99, v99
    v_cvt_pk_bf16_f32 v138, v96, v97
    v_cvt_pk_bf16_f32 v139, v98, v99
    v_mfma_f32_32x32x16_bf16 v[84:99], v[28:31], v[20:23], 0
    s_lshl3_add_u32 s17, s67, s12
    v_lshlrev_b32 v14, 7, v1
    s_mul_i32 s18, s66, 327680
    s_cmp_lt_u32 s17, 128
    s_mov_b32 s19, 0x9b0000
    s_cselect_b32 s19, 0x780000, s19
    s_add_u32 s18, s18, s19
    s_mul_i32 s17, s17, 2560
    s_add_u32 s18, s18, s17
    s_mov_b64 exec, 0xfffff
    buffer_load_dword v15, v14, s[4:7], s18 offen sc1
    s_mov_b64 exec, -1
    v_exp_f32 v68, v68
    v_exp_f32 v69, v69
    v_exp_f32 v70, v70
    v_exp_f32 v71, v71
    v_cvt_pk_bf16_f32 v132, v68, v69
    v_cvt_pk_bf16_f32 v133, v70, v71
    v_mfma_f32_32x32x8_bf16 v[84:99], v[44:45], v[26:27], v[84:99]
    s_setprio 0
    v_exp_f32 v72, v72
    v_exp_f32 v73, v73
    v_exp_f32 v74, v74
    v_exp_f32 v75, v75
    v_cvt_pk_bf16_f32 v134, v72, v73
    v_cvt_pk_bf16_f32 v135, v74, v75
    v_mfma_f32_32x32x16_bf16 v[116:131], v[64:67], v[136:139], v[116:131]
    s_waitcnt lgkmcnt(0)
    v_exp_f32 v76, v76
    v_exp_f32 v77, v77
    v_exp_f32 v78, v78
    v_exp_f32 v79, v79
    v_cvt_pk_bf16_f32 v136, v76, v77
    v_cvt_pk_bf16_f32 v137, v78, v79
    v_mfma_f32_32x32x16_bf16 v[100:115], v[52:55], v[132:135], v[100:115]
    ds_read_b128 v[60:63], v11 offset:2048
    v_exp_f32 v80, v80
    v_exp_f32 v81, v81
    v_exp_f32 v82, v82
    v_exp_f32 v83, v83
    v_cvt_pk_bf16_f32 v138, v80, v81
    v_cvt_pk_bf16_f32 v139, v82, v83
    v_mfma_f32_32x32x16_bf16 v[68:83], v[32:35], v[16:19], 0
    ds_read_b128 v[64:67], v11 offset:3072
    v_exp_f32 v84, v84
    v_exp_f32 v85, v85
    v_exp_f32 v86, v86
    v_exp_f32 v87, v87
    v_cvt_pk_bf16_f32 v132, v84, v85
    v_cvt_pk_bf16_f32 v133, v86, v87
    v_mfma_f32_32x32x8_bf16 v[68:83], v[46:47], v[24:25], v[68:83]
    ds_read2_b64 v[36:39], v9 offset0:64 offset1:192
    v_exp_f32 v88, v88
    v_exp_f32 v89, v89
    v_exp_f32 v90, v90
    v_exp_f32 v91, v91
    v_cvt_pk_bf16_f32 v134, v88, v89
    v_cvt_pk_bf16_f32 v135, v90, v91
    v_mfma_f32_32x32x16_bf16 v[100:115], v[56:59], v[136:139], v[100:115]
    ds_read2_b64 v[40:43], v9 offset0:65 offset1:193
    v_exp_f32 v92, v92
    v_exp_f32 v93, v93
    v_exp_f32 v94, v94
    v_exp_f32 v95, v95
    v_cvt_pk_bf16_f32 v136, v92, v93
    v_cvt_pk_bf16_f32 v137, v94, v95
    v_mfma_f32_32x32x16_bf16 v[116:131], v[52:55], v[132:135], v[116:131]
    ds_read_b128 v[48:51], v10 offset:512
    v_exp_f32 v96, v96
    v_exp_f32 v97, v97
    v_exp_f32 v98, v98
    v_exp_f32 v99, v99
    v_cvt_pk_bf16_f32 v138, v96, v97
    v_cvt_pk_bf16_f32 v139, v98, v99
    v_mfma_f32_32x32x16_bf16 v[84:99], v[32:35], v[20:23], 0
    v_exp_f32 v68, v68
    v_exp_f32 v69, v69
    v_exp_f32 v70, v70
    v_exp_f32 v71, v71
    v_cvt_pk_bf16_f32 v132, v68, v69
    v_cvt_pk_bf16_f32 v133, v70, v71
    v_mfma_f32_32x32x8_bf16 v[84:99], v[46:47], v[26:27], v[84:99]
    v_exp_f32 v72, v72
    v_exp_f32 v73, v73
    v_exp_f32 v74, v74
    v_exp_f32 v75, v75
    v_cvt_pk_bf16_f32 v134, v72, v73
    v_cvt_pk_bf16_f32 v135, v74, v75
    v_mfma_f32_32x32x16_bf16 v[116:131], v[56:59], v[136:139], v[116:131]
    s_waitcnt lgkmcnt(0)
    v_exp_f32 v76, v76
    v_exp_f32 v77, v77
    v_exp_f32 v78, v78
    v_exp_f32 v79, v79
    v_cvt_pk_bf16_f32 v136, v76, v77
    v_cvt_pk_bf16_f32 v137, v78, v79
    v_mfma_f32_32x32x16_bf16 v[100:115], v[60:63], v[132:135], v[100:115]
    ds_read_b128 v[52:55], v11 offset:4096
    v_exp_f32 v80, v80
    v_exp_f32 v81, v81
    v_exp_f32 v82, v82
    v_exp_f32 v83, v83
    v_cvt_pk_bf16_f32 v138, v80, v81
    v_cvt_pk_bf16_f32 v139, v82, v83
    v_mfma_f32_32x32x16_bf16 v[68:83], v[36:39], v[16:19], 0
    ds_read_b128 v[56:59], v11 offset:5120
    v_exp_f32 v84, v84
    v_exp_f32 v85, v85
    v_exp_f32 v86, v86
    v_exp_f32 v87, v87
    v_cvt_pk_bf16_f32 v132, v84, v85
    v_cvt_pk_bf16_f32 v133, v86, v87
    v_mfma_f32_32x32x8_bf16 v[68:83], v[48:49], v[24:25], v[68:83]
    v_exp_f32 v88, v88
    v_exp_f32 v89, v89
    v_exp_f32 v90, v90
    v_exp_f32 v91, v91
    v_cvt_pk_bf16_f32 v134, v88, v89
    v_cvt_pk_bf16_f32 v135, v90, v91
    v_mfma_f32_32x32x16_bf16 v[100:115], v[64:67], v[136:139], v[100:115]
    v_exp_f32 v92, v92
    v_exp_f32 v93, v93
    v_exp_f32 v94, v94
    v_exp_f32 v95, v95
    v_cvt_pk_bf16_f32 v136, v92, v93
    v_cvt_pk_bf16_f32 v137, v94, v95
    v_mfma_f32_32x32x16_bf16 v[116:131], v[60:63], v[132:135], v[116:131]
    s_waitcnt vmcnt(12)
    s_barrier
    v_exp_f32 v96, v96
    v_exp_f32 v97, v97
    v_exp_f32 v98, v98
    v_exp_f32 v99, v99
    v_cvt_pk_bf16_f32 v138, v96, v97
    v_cvt_pk_bf16_f32 v139, v98, v99
    v_mfma_f32_32x32x16_bf16 v[84:99], v[36:39], v[20:23], 0
    s_add_u32 m0, s29, 26624
    s_add_u32 s18, s22, 0
    buffer_load_dwordx4 v7, s[8:11], s18 offen lds
    v_exp_f32 v68, v68
    v_exp_f32 v69, v69
    v_exp_f32 v70, v70
    v_exp_f32 v71, v71
    v_cvt_pk_bf16_f32 v132, v68, v69
    v_cvt_pk_bf16_f32 v133, v70, v71
    v_mfma_f32_32x32x8_bf16 v[84:99], v[48:49], v[26:27], v[84:99]
    s_setprio 3
    s_add_u32 m0, s29, 30720
    s_add_u32 s18, s22, 4096
    buffer_load_dwordx4 v7, s[8:11], s18 offen lds
    v_exp_f32 v72, v72
    v_exp_f32 v73, v73
    v_exp_f32 v74, v74
    v_exp_f32 v75, v75
    v_cvt_pk_bf16_f32 v134, v72, v73
    v_cvt_pk_bf16_f32 v135, v74, v75
    v_mfma_f32_32x32x16_bf16 v[116:131], v[64:67], v[136:139], v[116:131]
    s_waitcnt lgkmcnt(0)
    v_exp_f32 v76, v76
    v_exp_f32 v77, v77
    v_exp_f32 v78, v78
    v_exp_f32 v79, v79
    v_cvt_pk_bf16_f32 v136, v76, v77
    v_cvt_pk_bf16_f32 v137, v78, v79
    v_mfma_f32_32x32x16_bf16 v[100:115], v[52:55], v[132:135], v[100:115]
    ds_read_b128 v[60:63], v11 offset:6144
    v_exp_f32 v80, v80
    v_exp_f32 v81, v81
    v_exp_f32 v82, v82
    v_exp_f32 v83, v83
    v_cvt_pk_bf16_f32 v138, v80, v81
    v_cvt_pk_bf16_f32 v139, v82, v83
    v_mfma_f32_32x32x16_bf16 v[68:83], v[40:43], v[16:19], 0
    ds_read_b128 v[64:67], v11 offset:7168
    v_exp_f32 v84, v84
    v_exp_f32 v85, v85
    v_exp_f32 v86, v86
    v_exp_f32 v87, v87
    v_cvt_pk_bf16_f32 v132, v84, v85
    v_cvt_pk_bf16_f32 v133, v86, v87
    v_add_u32 v9, 0x3400, v9
    v_add_u32 v10, 0x3400, v10
    v_mfma_f32_32x32x8_bf16 v[68:83], v[50:51], v[24:25], v[68:83]
    ds_read2_b64 v[28:31], v9 offset0:0 offset1:128
    v_exp_f32 v88, v88
    v_exp_f32 v89, v89
    v_exp_f32 v90, v90
    v_exp_f32 v91, v91
    v_cvt_pk_bf16_f32 v134, v88, v89
    v_cvt_pk_bf16_f32 v135, v90, v91
    v_mfma_f32_32x32x16_bf16 v[100:115], v[56:59], v[136:139], v[100:115]
    ds_read2_b64 v[32:35], v9 offset0:1 offset1:129
    v_exp_f32 v92, v92
    v_exp_f32 v93, v93
    v_exp_f32 v94, v94
    v_exp_f32 v95, v95
    v_cvt_pk_bf16_f32 v136, v92, v93
    v_cvt_pk_bf16_f32 v137, v94, v95
    v_mfma_f32_32x32x16_bf16 v[116:131], v[52:55], v[132:135], v[116:131]
    ds_read_b128 v[44:47], v10 offset:0
    v_exp_f32 v96, v96
    v_exp_f32 v97, v97
    v_exp_f32 v98, v98
    v_exp_f32 v99, v99
    v_cvt_pk_bf16_f32 v138, v96, v97
    v_cvt_pk_bf16_f32 v139, v98, v99
    v_mfma_f32_32x32x16_bf16 v[84:99], v[40:43], v[20:23], 0
    s_add_u32 m0, s29, 34816
    s_add_u32 s18, s22, 8192
    buffer_load_dwordx4 v7, s[8:11], s18 offen lds
    v_exp_f32 v68, v68
    v_exp_f32 v69, v69
    v_exp_f32 v70, v70
    v_exp_f32 v71, v71
    v_cvt_pk_bf16_f32 v132, v68, v69
    v_cvt_pk_bf16_f32 v133, v70, v71
    v_mfma_f32_32x32x8_bf16 v[84:99], v[50:51], v[26:27], v[84:99]
    s_setprio 2
    s_add_u32 m0, s29, 38912
    s_add_u32 s18, s22, 12288
    buffer_load_dwordx4 v7, s[8:11], s18 offen lds
    v_exp_f32 v72, v72
    v_exp_f32 v73, v73
    v_exp_f32 v74, v74
    v_exp_f32 v75, v75
    v_cvt_pk_bf16_f32 v134, v72, v73
    v_cvt_pk_bf16_f32 v135, v74, v75
    v_mfma_f32_32x32x16_bf16 v[116:131], v[56:59], v[136:139], v[116:131]
    s_waitcnt lgkmcnt(0)
    v_exp_f32 v76, v76
    v_exp_f32 v77, v77
    v_exp_f32 v78, v78
    v_exp_f32 v79, v79
    v_cvt_pk_bf16_f32 v136, v76, v77
    v_cvt_pk_bf16_f32 v137, v78, v79
    v_add_u32 v11, 0x3400, v11
    v_mfma_f32_32x32x16_bf16 v[100:115], v[60:63], v[132:135], v[100:115]
    ds_read_b128 v[52:55], v11 offset:0
    v_exp_f32 v80, v80
    v_exp_f32 v81, v81
    v_exp_f32 v82, v82
    v_exp_f32 v83, v83
    v_cvt_pk_bf16_f32 v138, v80, v81
    v_cvt_pk_bf16_f32 v139, v82, v83
    v_mfma_f32_32x32x16_bf16 v[68:83], v[28:31], v[16:19], 0
    ds_read_b128 v[56:59], v11 offset:1024
    v_exp_f32 v84, v84
    v_exp_f32 v85, v85
    v_exp_f32 v86, v86
    v_exp_f32 v87, v87
    v_cvt_pk_bf16_f32 v132, v84, v85
    v_cvt_pk_bf16_f32 v133, v86, v87
    v_mfma_f32_32x32x8_bf16 v[68:83], v[44:45], v[24:25], v[68:83]
    s_add_u32 m0, s29, 43008
    s_add_u32 s18, s22, 16384
    buffer_load_dwordx4 v7, s[8:11], s18 offen lds
    v_exp_f32 v88, v88
    v_exp_f32 v89, v89
    v_exp_f32 v90, v90
    v_exp_f32 v91, v91
    v_cvt_pk_bf16_f32 v134, v88, v89
    v_cvt_pk_bf16_f32 v135, v90, v91
    v_mfma_f32_32x32x16_bf16 v[100:115], v[64:67], v[136:139], v[100:115]
    s_add_u32 m0, s29, 47104
    s_add_u32 s18, s22, 20480
    buffer_load_dwordx4 v7, s[8:11], s18 offen lds
    v_exp_f32 v92, v92
    v_exp_f32 v93, v93
    v_exp_f32 v94, v94
    v_exp_f32 v95, v95
    v_cvt_pk_bf16_f32 v136, v92, v93
    v_cvt_pk_bf16_f32 v137, v94, v95
    v_mfma_f32_32x32x16_bf16 v[116:131], v[60:63], v[132:135], v[116:131]
    s_add_u32 m0, s29, 51200
    s_add_u32 s18, s22, 24576
    buffer_load_dwordx4 v7, s[8:11], s18 offen lds
    s_add_u32 m0, s29, 55296
    s_add_u32 s18, s22, 28672
    buffer_load_dwordx4 v7, s[8:11], s18 offen lds
    s_add_u32 m0, s29, 59392
    s_add_u32 s18, s22, 32768
    buffer_load_dwordx4 v7, s[8:11], s18 offen lds
    v_exp_f32 v96, v96
    v_exp_f32 v97, v97
    v_exp_f32 v98, v98
    v_exp_f32 v99, v99
    v_cvt_pk_bf16_f32 v138, v96, v97
    v_cvt_pk_bf16_f32 v139, v98, v99
    v_mfma_f32_32x32x16_bf16 v[84:99], v[28:31], v[20:23], 0
    s_add_u32 m0, s29, 63488
    s_add_u32 s18, s22, 36864
    buffer_load_dwordx4 v7, s[8:11], s18 offen lds
    v_exp_f32 v68, v68
    v_exp_f32 v69, v69
    v_exp_f32 v70, v70
    v_exp_f32 v71, v71
    v_cvt_pk_bf16_f32 v132, v68, v69
    v_cvt_pk_bf16_f32 v133, v70, v71
    v_mfma_f32_32x32x8_bf16 v[84:99], v[44:45], v[26:27], v[84:99]
    s_setprio 1
    s_add_u32 m0, s29, 67584
    s_add_u32 s18, s22, 40960
    buffer_load_dwordx4 v7, s[8:11], s18 offen lds
    v_exp_f32 v72, v72
    v_exp_f32 v73, v73
    v_exp_f32 v74, v74
    v_exp_f32 v75, v75
    v_cvt_pk_bf16_f32 v134, v72, v73
    v_cvt_pk_bf16_f32 v135, v74, v75
    v_mfma_f32_32x32x16_bf16 v[116:131], v[64:67], v[136:139], v[116:131]
    s_waitcnt lgkmcnt(0)
    v_exp_f32 v76, v76
    v_exp_f32 v77, v77
    v_exp_f32 v78, v78
    v_exp_f32 v79, v79
    v_cvt_pk_bf16_f32 v136, v76, v77
    v_cvt_pk_bf16_f32 v137, v78, v79
    v_mfma_f32_32x32x16_bf16 v[100:115], v[52:55], v[132:135], v[100:115]
    ds_read_b128 v[60:63], v11 offset:2048
    v_exp_f32 v80, v80
    v_exp_f32 v81, v81
    v_exp_f32 v82, v82
    v_exp_f32 v83, v83
    v_cvt_pk_bf16_f32 v138, v80, v81
    v_cvt_pk_bf16_f32 v139, v82, v83
    v_mfma_f32_32x32x16_bf16 v[68:83], v[32:35], v[16:19], 0
    ds_read_b128 v[64:67], v11 offset:3072
    v_exp_f32 v84, v84
    v_exp_f32 v85, v85
    v_exp_f32 v86, v86
    v_exp_f32 v87, v87
    v_cvt_pk_bf16_f32 v132, v84, v85
    v_cvt_pk_bf16_f32 v133, v86, v87
    v_mfma_f32_32x32x8_bf16 v[68:83], v[46:47], v[24:25], v[68:83]
    ds_read2_b64 v[36:39], v9 offset0:64 offset1:192
    v_exp_f32 v88, v88
    v_exp_f32 v89, v89
    v_exp_f32 v90, v90
    v_exp_f32 v91, v91
    v_cvt_pk_bf16_f32 v134, v88, v89
    v_cvt_pk_bf16_f32 v135, v90, v91
    v_mfma_f32_32x32x16_bf16 v[100:115], v[56:59], v[136:139], v[100:115]
    ds_read2_b64 v[40:43], v9 offset0:65 offset1:193
    v_exp_f32 v92, v92
    v_exp_f32 v93, v93
    v_exp_f32 v94, v94
    v_exp_f32 v95, v95
    v_cvt_pk_bf16_f32 v136, v92, v93
    v_cvt_pk_bf16_f32 v137, v94, v95
    v_mfma_f32_32x32x16_bf16 v[116:131], v[52:55], v[132:135], v[116:131]
    ds_read_b128 v[48:51], v10 offset:512
    v_exp_f32 v96, v96
    v_exp_f32 v97, v97
    v_exp_f32 v98, v98
    v_exp_f32 v99, v99
    v_cvt_pk_bf16_f32 v138, v96, v97
    v_cvt_pk_bf16_f32 v139, v98, v99
    v_mfma_f32_32x32x16_bf16 v[84:99], v[32:35], v[20:23], 0
    s_add_u32 m0, s29, 71680
    s_add_u32 s18, s22, 45056
    buffer_load_dwordx4 v7, s[8:11], s18 offen lds
    v_exp_f32 v68, v68
    v_exp_f32 v69, v69
    v_exp_f32 v70, v70
    v_exp_f32 v71, v71
    v_cvt_pk_bf16_f32 v132, v68, v69
    v_cvt_pk_bf16_f32 v133, v70, v71
    v_mfma_f32_32x32x8_bf16 v[84:99], v[46:47], v[26:27], v[84:99]
    s_setprio 0
    s_add_u32 m0, s29, 75776
    s_add_u32 s18, s22, 49152
    buffer_load_dwordx4 v7, s[8:11], s18 offen lds
    v_exp_f32 v72, v72
    v_exp_f32 v73, v73
    v_exp_f32 v74, v74
    v_exp_f32 v75, v75
    v_cvt_pk_bf16_f32 v134, v72, v73
    v_cvt_pk_bf16_f32 v135, v74, v75
    v_mfma_f32_32x32x16_bf16 v[116:131], v[56:59], v[136:139], v[116:131]
    s_waitcnt lgkmcnt(0)
    v_exp_f32 v76, v76
    v_exp_f32 v77, v77
    v_exp_f32 v78, v78
    v_exp_f32 v79, v79
    v_cvt_pk_bf16_f32 v136, v76, v77
    v_cvt_pk_bf16_f32 v137, v78, v79
    v_mfma_f32_32x32x16_bf16 v[100:115], v[60:63], v[132:135], v[100:115]
    ds_read_b128 v[52:55], v11 offset:4096
    v_exp_f32 v80, v80
    v_exp_f32 v81, v81
    v_exp_f32 v82, v82
    v_exp_f32 v83, v83
    v_cvt_pk_bf16_f32 v138, v80, v81
    v_cvt_pk_bf16_f32 v139, v82, v83
    v_mfma_f32_32x32x16_bf16 v[68:83], v[36:39], v[16:19], 0
    ds_read_b128 v[56:59], v11 offset:5120
    v_exp_f32 v84, v84
    v_exp_f32 v85, v85
    v_exp_f32 v86, v86
    v_exp_f32 v87, v87
    v_cvt_pk_bf16_f32 v132, v84, v85
    v_cvt_pk_bf16_f32 v133, v86, v87
    v_mfma_f32_32x32x8_bf16 v[68:83], v[48:49], v[24:25], v[68:83]
    s_lshl3_add_u32 s17, s67, s12
    s_lshl_b32 s18, s66, 8
    s_add_u32 s17, s17, s18
    s_mul_i32 s18, s17, 3072
    s_add_u32 s18, s18, 0xc80000
    s_mov_b64 exec, 0xffffff
    buffer_load_dword v15, v14, s[4:7], s18 offen sc1
    s_mov_b64 exec, -1
    v_exp_f32 v88, v88
    v_exp_f32 v89, v89
    v_exp_f32 v90, v90
    v_exp_f32 v91, v91
    v_cvt_pk_bf16_f32 v134, v88, v89
    v_cvt_pk_bf16_f32 v135, v90, v91
    v_mfma_f32_32x32x16_bf16 v[100:115], v[64:67], v[136:139], v[100:115]
    s_lshl3_add_u32 s17, s67, s12
    s_lshl_b32 s18, s66, 14
    s_add_u32 s18, s18, 0x12c0000
    s_lshl_b32 s19, s66, 10
    s_add_u32 s19, s19, 0x12ec000
    s_cmp_lt_u32 s17, 128
    s_cselect_b32 s18, s18, s19
    s_add_u32 s19, s19, 7168
    s_cmp_lt_u32 s17, 136
    s_cselect_b32 s18, s18, s19
    s_min_u32 s17, s17, 143
    s_lshl_b32 s17, s17, 7
    s_add_u32 s18, s18, s17
    s_mov_b64 exec, 0x1
    buffer_load_dword v15, v14, s[4:7], s18 offen sc1
    s_mov_b64 exec, -1
    v_exp_f32 v92, v92
    v_exp_f32 v93, v93
    v_exp_f32 v94, v94
    v_exp_f32 v95, v95
    v_cvt_pk_bf16_f32 v136, v92, v93
    v_cvt_pk_bf16_f32 v137, v94, v95
    v_mfma_f32_32x32x16_bf16 v[116:131], v[60:63], v[132:135], v[116:131]
    s_waitcnt vmcnt(27)
    s_barrier
    s_mul_i32 s17, s13, 3072
    s_mul_i32 s18, s14, 79872
    s_add_u32 s19, s17, s18
    v_add_u32 v2, s19, v7
    s_sub_u32 s18, 79872, s18
    s_add_u32 s19, s17, s18
    v_add_u32 v3, s19, v7
    v_bfe_u32 v12, v1, 4, 1
    v_mul_u32_u24 v12, 20480, v12
    v_and_b32 v13, 15, v1
    v_lshl_add_u32 v12, v13, 4, v12
    v_lshl_add_u32 v13, v6, 8, v12
    v_exp_f32 v96, v96
    v_exp_f32 v97, v97
    v_exp_f32 v98, v98
    v_exp_f32 v99, v99
    v_cvt_pk_bf16_f32 v138, v96, v97
    v_cvt_pk_bf16_f32 v139, v98, v99
    v_mfma_f32_32x32x16_bf16 v[84:99], v[36:39], v[20:23], 0
    v_exp_f32 v68, v68
    v_exp_f32 v69, v69
    v_exp_f32 v70, v70
    v_exp_f32 v71, v71
    v_cvt_pk_bf16_f32 v132, v68, v69
    v_cvt_pk_bf16_f32 v133, v70, v71
    v_mfma_f32_32x32x8_bf16 v[84:99], v[48:49], v[26:27], v[84:99]
    s_setprio 3
    v_exp_f32 v72, v72
    v_exp_f32 v73, v73
    v_exp_f32 v74, v74
    v_exp_f32 v75, v75
    v_cvt_pk_bf16_f32 v134, v72, v73
    v_cvt_pk_bf16_f32 v135, v74, v75
    v_mfma_f32_32x32x16_bf16 v[116:131], v[64:67], v[136:139], v[116:131]
    s_waitcnt lgkmcnt(0)
    v_exp_f32 v76, v76
    v_exp_f32 v77, v77
    v_exp_f32 v78, v78
    v_exp_f32 v79, v79
    v_cvt_pk_bf16_f32 v136, v76, v77
    v_cvt_pk_bf16_f32 v137, v78, v79
    v_mfma_f32_32x32x16_bf16 v[100:115], v[52:55], v[132:135], v[100:115]
    ds_read_b128 v[60:63], v11 offset:6144
    v_exp_f32 v80, v80
    v_exp_f32 v81, v81
    v_exp_f32 v82, v82
    v_exp_f32 v83, v83
    v_cvt_pk_bf16_f32 v138, v80, v81
    v_cvt_pk_bf16_f32 v139, v82, v83
    v_mfma_f32_32x32x16_bf16 v[68:83], v[40:43], v[16:19], 0
    ds_read_b128 v[64:67], v11 offset:7168
    v_exp_f32 v84, v84
    v_exp_f32 v85, v85
    v_exp_f32 v86, v86
    v_exp_f32 v87, v87
    v_cvt_pk_bf16_f32 v132, v84, v85
    v_cvt_pk_bf16_f32 v133, v86, v87
    v_mfma_f32_32x32x8_bf16 v[68:83], v[50:51], v[24:25], v[68:83]
    s_setprio 2
    v_exp_f32 v88, v88
    v_exp_f32 v89, v89
    v_exp_f32 v90, v90
    v_exp_f32 v91, v91
    v_cvt_pk_bf16_f32 v134, v88, v89
    v_cvt_pk_bf16_f32 v135, v90, v91
    v_mfma_f32_32x32x16_bf16 v[100:115], v[56:59], v[136:139], v[100:115]
    v_exp_f32 v92, v92
    v_exp_f32 v93, v93
    v_exp_f32 v94, v94
    v_exp_f32 v95, v95
    v_cvt_pk_bf16_f32 v136, v92, v93
    v_cvt_pk_bf16_f32 v137, v94, v95
    v_mfma_f32_32x32x16_bf16 v[116:131], v[52:55], v[132:135], v[116:131]
    v_exp_f32 v96, v96
    v_exp_f32 v97, v97
    v_exp_f32 v98, v98
    v_exp_f32 v99, v99
    v_cvt_pk_bf16_f32 v138, v96, v97
    v_cvt_pk_bf16_f32 v139, v98, v99
    v_mfma_f32_32x32x16_bf16 v[84:99], v[40:43], v[20:23], 0
    v_exp_f32 v68, v68
    v_exp_f32 v69, v69
    v_exp_f32 v70, v70
    v_exp_f32 v71, v71
    v_cvt_pk_bf16_f32 v132, v68, v69
    v_cvt_pk_bf16_f32 v133, v70, v71
    v_mfma_f32_32x32x8_bf16 v[84:99], v[50:51], v[26:27], v[84:99]
    s_setprio 1
    v_exp_f32 v72, v72
    v_exp_f32 v73, v73
    v_exp_f32 v74, v74
    v_exp_f32 v75, v75
    v_cvt_pk_bf16_f32 v134, v72, v73
    v_cvt_pk_bf16_f32 v135, v74, v75
    v_mfma_f32_32x32x16_bf16 v[116:131], v[56:59], v[136:139], v[116:131]
    s_waitcnt lgkmcnt(0)
    v_exp_f32 v76, v76
    v_exp_f32 v77, v77
    v_exp_f32 v78, v78
    v_exp_f32 v79, v79
    v_cvt_pk_bf16_f32 v136, v76, v77
    v_cvt_pk_bf16_f32 v137, v78, v79
    v_mfma_f32_32x32x16_bf16 v[100:115], v[60:63], v[132:135], v[100:115]
    v_exp_f32 v80, v80
    v_exp_f32 v81, v81
    v_exp_f32 v82, v82
    v_exp_f32 v83, v83
    v_cvt_pk_bf16_f32 v138, v80, v81
    v_cvt_pk_bf16_f32 v139, v82, v83
    v_exp_f32 v84, v84
    v_exp_f32 v85, v85
    v_exp_f32 v86, v86
    v_exp_f32 v87, v87
    v_cvt_pk_bf16_f32 v132, v84, v85
    v_cvt_pk_bf16_f32 v133, v86, v87
    s_setprio 0
    v_exp_f32 v88, v88
    v_exp_f32 v89, v89
    v_exp_f32 v90, v90
    v_exp_f32 v91, v91
    v_cvt_pk_bf16_f32 v134, v88, v89
    v_cvt_pk_bf16_f32 v135, v90, v91
    v_mfma_f32_32x32x16_bf16 v[100:115], v[64:67], v[136:139], v[100:115]
    v_exp_f32 v92, v92
    v_exp_f32 v93, v93
    v_exp_f32 v94, v94
    v_exp_f32 v95, v95
    v_cvt_pk_bf16_f32 v136, v92, v93
    v_cvt_pk_bf16_f32 v137, v94, v95
    v_mfma_f32_32x32x16_bf16 v[116:131], v[60:63], v[132:135], v[116:131]
    v_exp_f32 v96, v96
    v_exp_f32 v97, v97
    v_exp_f32 v98, v98
    v_exp_f32 v99, v99
    v_cvt_pk_bf16_f32 v138, v96, v97
    v_cvt_pk_bf16_f32 v139, v98, v99
    s_nop 1
    v_mfma_f32_32x32x16_bf16 v[116:131], v[64:67], v[136:139], v[116:131]
F_tail:
    s_setprio 0
    v_pk_mul_f32 v[84:85], v[100:101], v[100:101]
    v_pk_fma_f32 v[84:85], v[102:103], v[102:103], v[84:85]
    v_pk_fma_f32 v[84:85], v[104:105], v[104:105], v[84:85]
    v_pk_fma_f32 v[84:85], v[106:107], v[106:107], v[84:85]
    v_pk_fma_f32 v[84:85], v[108:109], v[108:109], v[84:85]
    v_pk_fma_f32 v[84:85], v[110:111], v[110:111], v[84:85]
    s_nop 4
    ds_write_b128 v2, v[116:119] offset:0
    ds_write_b128 v2, v[120:123] offset:1024
    ds_write_b128 v2, v[124:127] offset:2048
    v_pk_fma_f32 v[84:85], v[116:117], v[116:117], v[84:85]
    v_pk_fma_f32 v[84:85], v[118:119], v[118:119], v[84:85]
    v_pk_fma_f32 v[84:85], v[120:121], v[120:121], v[84:85]
    v_pk_fma_f32 v[84:85], v[122:123], v[122:123], v[84:85]
    v_pk_fma_f32 v[84:85], v[124:125], v[124:125], v[84:85]
    v_pk_fma_f32 v[84:85], v[126:127], v[126:127], v[84:85]
    v_add_f32 v84, v84, v85
    s_mov_b32 s17, 0x7f800000
    v_cmp_ngt_f32 vcc, s17, v84
    v_mov_b32 v2, 159744
    s_cbranch_vccz F_good
    v_mov_b32 v4, 1
    ds_write_b32 v2, v4
F_good:
    s_waitcnt lgkmcnt(0)
    s_barrier
    ds_read_b128 v[76:79], v3 offset:2048
    ds_read_b32 v4, v2
    ds_read_b128 v[68:71], v3 offset:0
    ds_read_b128 v[72:75], v3 offset:1024
    s_waitcnt lgkmcnt(2)
    v_add_f32 v84, v108, v76
    v_add_f32 v85, v108, v76
    v_readfirstlane_b32 s17, v4
    v_pk_add_f32 v[108:109], v[108:109], v[76:77]
    v_pk_add_f32 v[110:111], v[110:111], v[78:79]
    v_permlane32_swap_b32 v84, v85
    s_cmp_gt_u32 s17, s23
    s_cbranch_scc1 F_retry
    v_rcp_f32 v84, v85
    s_waitcnt lgkmcnt(0)
    v_pk_add_f32 v[100:101], v[100:101], v[68:69]
    v_pk_add_f32 v[102:103], v[102:103], v[70:71]
    v_pk_add_f32 v[104:105], v[104:105], v[72:73]
    v_pk_add_f32 v[106:107], v[106:107], v[74:75]
    v_pk_mul_f32 v[100:101], v[100:101], v[84:85] op_sel_hi:[1,0]
    v_pk_mul_f32 v[102:103], v[102:103], v[84:85] op_sel_hi:[1,0]
    v_pk_mul_f32 v[104:105], v[104:105], v[84:85] op_sel_hi:[1,0]
    v_pk_mul_f32 v[106:107], v[106:107], v[84:85] op_sel_hi:[1,0]
    v_cvt_pk_bf16_f32 v132, v100, v101
    v_cvt_pk_bf16_f32 v133, v102, v103
    v_cvt_pk_bf16_f32 v134, v104, v105
    v_cvt_pk_bf16_f32 v135, v106, v107
    s_cmp_eq_u32 s6, 0
    s_cbranch_scc1 F_st0
    buffer_store_dwordx4 v[132:135], v13, s[8:11], s69 offen nt
F_sb0:
    v_pk_mul_f32 v[108:109], v[108:109], v[84:85] op_sel_hi:[1,0]
    v_pk_mul_f32 v[110:111], v[110:111], v[84:85] op_sel_hi:[1,0]
    v_cvt_pk_bf16_f32 v136, v108, v109
    v_cvt_pk_bf16_f32 v137, v110, v111
    s_mov_b32 exec_hi, 0
    s_cmp_eq_u32 s6, 0
    s_cbranch_scc1 F_st1
    buffer_store_dwordx2 v[136:137], v12, s[8:11], s68 offen
F_sb1:
    s_mov_b32 exec_hi, -1
    s_lshl_b32 s17, s64, 7
    s_lshl2_add_u32 s17, s67, s17
    s_add_u32 s17, s17, 19464192
    v_mov_b32 v2, 0
    v_mov_b32 v3, 1
    s_mov_b64 exec, 1
    s_waitcnt vmcnt(0)
    s_cmp_eq_u32 s6, 0
    s_cbranch_scc1 F_st2
    buffer_store_dword v3, v2, s[8:11], s17 offen
F_sb2:
    s_mov_b64 exec, -1
    s_cmp_lg_u32 s14, 0
    s_cbranch_scc1 F_helper
    s_and_b32 s26, s13, 1
    s_lshr_b32 s27, s13, 1
    s_lshl1_add_u32 s29, s56, s26
    s_lshl_b32 s20, s27, 4
    s_lshl_b32 s61, s29, 7
    s_lshl2_add_u32 s61, s20, s61
    s_add_u32 s61, s61, 19464192
    v_and_b32 v4, 15, v1
    v_lshlrev_b32 v4, 2, v4
    s_mov_b32 s19, 65536
    buffer_load_dword v5, v4, s[8:11], s61 offen sc1
    v_add_u32 v2, s30, v7
    s_barrier
    ds_read_b128 v[8:11], v150 offset:0
    ds_read_b128 v[12:15], v150 offset:1024
    ds_read_b128 v[16:19], v150 offset:2048
    ds_read_b128 v[20:23], v150 offset:3072
    ds_read_b128 v[24:27], v150 offset:4096
    ds_read_b128 v[28:31], v150 offset:5120
    ds_read_b128 v[32:35], v150 offset:6144
    ds_read_b128 v[36:39], v150 offset:7168
    ds_read_b128 v[40:43], v150 offset:8192
    ds_read_b128 v[44:47], v150 offset:9216
    ds_write_b128 v2, v[160:163] offset:0
    ds_write_b128 v2, v[164:167] offset:4096
    ds_write_b128 v2, v[168:171] offset:8192
    ds_write_b128 v2, v[172:175] offset:12288
    ds_write_b128 v2, v[176:179] offset:16384
    ds_write_b128 v2, v[180:183] offset:20480
    s_mul_i32 s21, s29, 40960
    s_mul_i32 s17, s27, 10240
    s_add_u32 s21, s21, s17
    s_add_u32 s21, s21, 7864320
    s_add_u32 s24, s21, 10240
    s_sub_u32 s17, s57, 5
    s_min_u32 s17, s17, s57
    s_mul_i32 s17, s17, 2048
    s_add_u32 s62, s21, s17
    s_mul_i32 s17, s27, 20480
    v_add_u32 v158, s17, v7
    s_sub_u32 s17, 20480, s17
    v_add_u32 v159, s17, v7
    s_waitcnt lgkmcnt(0)
    s_mul_i32 s17, s13, 5120
    s_add_u32 s17, s17, 79872
    v_add_u32 v2, s17, v7
    s_xor_b32 s17, s13, 2
    s_mul_i32 s17, s17, 5120
    s_add_u32 s17, s17, 79872
    v_add_u32 v3, s17, v7
F_pollc:
    s_waitcnt vmcnt(0)
    v_cmp_ne_u32 vcc, 1, v5
    s_cbranch_vccz F_pollxc
    buffer_load_dword v5, v4, s[8:11], s61 offen sc1
    s_sub_u32 s19, s19, 1
    s_cbranch_scc0 F_pollc
F_pollxc:
    buffer_load_dwordx4 v[108:111], v158, s[8:11], s62 offen offset:0 sc1
    buffer_load_dwordx4 v[112:115], v159, s[8:11], s62 offen offset:0 sc1
    buffer_load_dwordx4 v[116:119], v158, s[8:11], s62 offen offset:1024 sc1
    buffer_load_dwordx4 v[120:123], v159, s[8:11], s62 offen offset:1024 sc1
    s_add_u32 s62, s62, 2048
    s_cmp_eq_u32 s62, s24
    s_cselect_b32 s62, s21, s62
    buffer_load_dwordx4 v[124:127], v158, s[8:11], s62 offen offset:0 sc1
    buffer_load_dwordx4 v[128:131], v159, s[8:11], s62 offen offset:0 sc1
    buffer_load_dwordx4 v[132:135], v158, s[8:11], s62 offen offset:1024 sc1
    buffer_load_dwordx4 v[136:139], v159, s[8:11], s62 offen offset:1024 sc1
    s_add_u32 s62, s62, 2048
    s_cmp_eq_u32 s62, s24
    s_cselect_b32 s62, s21, s62
    s_waitcnt vmcnt(6) lgkmcnt(5)
    v_mfma_f32_16x16x32_bf16 v[68:71], v[8:11], v[108:111], 0
    ds_read_b128 v[48:51], v150 offset:10240
    v_mfma_f32_16x16x32_bf16 v[88:91], v[8:11], v[112:115], 0
    v_mfma_f32_16x16x32_bf16 v[72:75], v[12:15], v[108:111], 0
    ds_read_b128 v[52:55], v150 offset:11264
    v_mfma_f32_16x16x32_bf16 v[92:95], v[12:15], v[112:115], 0
    v_mfma_f32_16x16x32_bf16 v[76:79], v[16:19], v[108:111], 0
    ds_read_b128 v[56:59], v150 offset:12288
    v_mfma_f32_16x16x32_bf16 v[96:99], v[16:19], v[112:115], 0
    v_mfma_f32_16x16x32_bf16 v[80:83], v[20:23], v[108:111], 0
    ds_read_b128 v[60:63], v150 offset:13312
    v_mfma_f32_16x16x32_bf16 v[100:103], v[20:23], v[112:115], 0
    v_mfma_f32_16x16x32_bf16 v[84:87], v[24:27], v[108:111], 0
    ds_read_b128 v[64:67], v150 offset:14336
    v_mfma_f32_16x16x32_bf16 v[104:107], v[24:27], v[112:115], 0
    s_waitcnt vmcnt(4) lgkmcnt(5)
    v_mfma_f32_16x16x32_bf16 v[68:71], v[28:31], v[116:119], v[68:71]
    ds_read_b128 v[8:11], v150 offset:15360
    v_mfma_f32_16x16x32_bf16 v[88:91], v[28:31], v[120:123], v[88:91]
    v_mfma_f32_16x16x32_bf16 v[72:75], v[32:35], v[116:119], v[72:75]
    ds_read_b128 v[12:15], v150 offset:16384
    v_mfma_f32_16x16x32_bf16 v[92:95], v[32:35], v[120:123], v[92:95]
    buffer_load_dwordx4 v[108:111], v158, s[8:11], s62 offen offset:0 sc1
    v_mfma_f32_16x16x32_bf16 v[76:79], v[36:39], v[116:119], v[76:79]
    ds_read_b128 v[16:19], v150 offset:17408
    v_mfma_f32_16x16x32_bf16 v[96:99], v[36:39], v[120:123], v[96:99]
    v_mfma_f32_16x16x32_bf16 v[80:83], v[40:43], v[116:119], v[80:83]
    ds_read_b128 v[20:23], v150 offset:18432
    v_mfma_f32_16x16x32_bf16 v[100:103], v[40:43], v[120:123], v[100:103]
    buffer_load_dwordx4 v[112:115], v159, s[8:11], s62 offen offset:0 sc1
    v_mfma_f32_16x16x32_bf16 v[84:87], v[44:47], v[116:119], v[84:87]
    ds_read_b128 v[24:27], v150 offset:19456
    v_mfma_f32_16x16x32_bf16 v[104:107], v[44:47], v[120:123], v[104:107]
    s_waitcnt vmcnt(4) lgkmcnt(5)
    v_mfma_f32_16x16x32_bf16 v[68:71], v[48:51], v[124:127], v[68:71]
    ds_read_b128 v[28:31], v150 offset:20480
    v_mfma_f32_16x16x32_bf16 v[88:91], v[48:51], v[128:131], v[88:91]
    v_mfma_f32_16x16x32_bf16 v[72:75], v[52:55], v[124:127], v[72:75]
    ds_read_b128 v[32:35], v150 offset:21504
    v_mfma_f32_16x16x32_bf16 v[92:95], v[52:55], v[128:131], v[92:95]
    buffer_load_dwordx4 v[116:119], v158, s[8:11], s62 offen offset:1024 sc1
    v_mfma_f32_16x16x32_bf16 v[76:79], v[56:59], v[124:127], v[76:79]
    ds_read_b128 v[36:39], v150 offset:22528
    v_mfma_f32_16x16x32_bf16 v[96:99], v[56:59], v[128:131], v[96:99]
    v_mfma_f32_16x16x32_bf16 v[80:83], v[60:63], v[124:127], v[80:83]
    ds_read_b128 v[40:43], v150 offset:23552
    v_mfma_f32_16x16x32_bf16 v[100:103], v[60:63], v[128:131], v[100:103]
    buffer_load_dwordx4 v[120:123], v159, s[8:11], s62 offen offset:1024 sc1
    s_add_u32 s62, s62, 2048
    s_cmp_eq_u32 s62, s24
    s_cselect_b32 s62, s21, s62
    v_mfma_f32_16x16x32_bf16 v[84:87], v[64:67], v[124:127], v[84:87]
    ds_read_b128 v[44:47], v150 offset:24576
    v_mfma_f32_16x16x32_bf16 v[104:107], v[64:67], v[128:131], v[104:107]
    s_waitcnt vmcnt(4) lgkmcnt(5)
    v_mfma_f32_16x16x32_bf16 v[68:71], v[8:11], v[132:135], v[68:71]
    ds_read_b128 v[48:51], v150 offset:25600
    v_mfma_f32_16x16x32_bf16 v[88:91], v[8:11], v[136:139], v[88:91]
    v_mfma_f32_16x16x32_bf16 v[72:75], v[12:15], v[132:135], v[72:75]
    ds_read_b128 v[52:55], v150 offset:26624
    v_mfma_f32_16x16x32_bf16 v[92:95], v[12:15], v[136:139], v[92:95]
    buffer_load_dwordx4 v[124:127], v158, s[8:11], s62 offen offset:0 sc1
    v_mfma_f32_16x16x32_bf16 v[76:79], v[16:19], v[132:135], v[76:79]
    ds_read_b128 v[56:59], v150 offset:27648
    v_mfma_f32_16x16x32_bf16 v[96:99], v[16:19], v[136:139], v[96:99]
    v_mfma_f32_16x16x32_bf16 v[80:83], v[20:23], v[132:135], v[80:83]
    ds_read_b128 v[60:63], v150 offset:28672
    v_mfma_f32_16x16x32_bf16 v[100:103], v[20:23], v[136:139], v[100:103]
    buffer_load_dwordx4 v[128:131], v159, s[8:11], s62 offen offset:0 sc1
    v_mfma_f32_16x16x32_bf16 v[84:87], v[24:27], v[132:135], v[84:87]
    ds_read_b128 v[64:67], v150 offset:29696
    v_mfma_f32_16x16x32_bf16 v[104:107], v[24:27], v[136:139], v[104:107]
    s_waitcnt vmcnt(4) lgkmcnt(5)
    v_mfma_f32_16x16x32_bf16 v[68:71], v[28:31], v[108:111], v[68:71]
    ds_read_b128 v[8:11], v150 offset:30720
    v_mfma_f32_16x16x32_bf16 v[88:91], v[28:31], v[112:115], v[88:91]
    v_mfma_f32_16x16x32_bf16 v[72:75], v[32:35], v[108:111], v[72:75]
    ds_read_b128 v[12:15], v150 offset:31744
    v_mfma_f32_16x16x32_bf16 v[92:95], v[32:35], v[112:115], v[92:95]
    buffer_load_dwordx4 v[132:135], v158, s[8:11], s62 offen offset:1024 sc1
    v_mfma_f32_16x16x32_bf16 v[76:79], v[36:39], v[108:111], v[76:79]
    ds_read_b128 v[16:19], v150 offset:32768
    v_mfma_f32_16x16x32_bf16 v[96:99], v[36:39], v[112:115], v[96:99]
    v_mfma_f32_16x16x32_bf16 v[80:83], v[40:43], v[108:111], v[80:83]
    ds_read_b128 v[20:23], v150 offset:33792
    v_mfma_f32_16x16x32_bf16 v[100:103], v[40:43], v[112:115], v[100:103]
    buffer_load_dwordx4 v[136:139], v159, s[8:11], s62 offen offset:1024 sc1
    s_add_u32 s62, s62, 2048
    s_cmp_eq_u32 s62, s24
    s_cselect_b32 s62, s21, s62
    v_mfma_f32_16x16x32_bf16 v[84:87], v[44:47], v[108:111], v[84:87]
    ds_read_b128 v[24:27], v150 offset:34816
    v_mfma_f32_16x16x32_bf16 v[104:107], v[44:47], v[112:115], v[104:107]
    s_waitcnt vmcnt(4) lgkmcnt(5)
    v_mfma_f32_16x16x32_bf16 v[68:71], v[48:51], v[116:119], v[68:71]
    ds_read_b128 v[28:31], v150 offset:35840
    v_mfma_f32_16x16x32_bf16 v[88:91], v[48:51], v[120:123], v[88:91]
    v_mfma_f32_16x16x32_bf16 v[72:75], v[52:55], v[116:119], v[72:75]
    ds_read_b128 v[32:35], v150 offset:36864
    v_mfma_f32_16x16x32_bf16 v[92:95], v[52:55], v[120:123], v[92:95]
    buffer_load_dwordx4 v[108:111], v158, s[8:11], s62 offen offset:0 sc1
    v_mfma_f32_16x16x32_bf16 v[76:79], v[56:59], v[116:119], v[76:79]
    ds_read_b128 v[36:39], v150 offset:37888
    v_mfma_f32_16x16x32_bf16 v[96:99], v[56:59], v[120:123], v[96:99]
    v_mfma_f32_16x16x32_bf16 v[80:83], v[60:63], v[116:119], v[80:83]
    ds_read_b128 v[40:43], v150 offset:38912
    v_mfma_f32_16x16x32_bf16 v[100:103], v[60:63], v[120:123], v[100:103]
    buffer_load_dwordx4 v[112:115], v159, s[8:11], s62 offen offset:0 sc1
    v_mfma_f32_16x16x32_bf16 v[84:87], v[64:67], v[116:119], v[84:87]
    ds_read_b128 v[44:47], v150 offset:39936
    v_mfma_f32_16x16x32_bf16 v[104:107], v[64:67], v[120:123], v[104:107]
    s_waitcnt vmcnt(4) lgkmcnt(5)
    v_mfma_f32_16x16x32_bf16 v[68:71], v[8:11], v[124:127], v[68:71]
    ds_read_b128 v[48:51], v150 offset:40960
    v_mfma_f32_16x16x32_bf16 v[88:91], v[8:11], v[128:131], v[88:91]
    v_mfma_f32_16x16x32_bf16 v[72:75], v[12:15], v[124:127], v[72:75]
    ds_read_b128 v[52:55], v150 offset:41984
    v_mfma_f32_16x16x32_bf16 v[92:95], v[12:15], v[128:131], v[92:95]
    buffer_load_dwordx4 v[116:119], v158, s[8:11], s62 offen offset:1024 sc1
    v_mfma_f32_16x16x32_bf16 v[76:79], v[16:19], v[124:127], v[76:79]
    ds_read_b128 v[56:59], v150 offset:43008
    v_mfma_f32_16x16x32_bf16 v[96:99], v[16:19], v[128:131], v[96:99]
    v_mfma_f32_16x16x32_bf16 v[80:83], v[20:23], v[124:127], v[80:83]
    ds_read_b128 v[60:63], v150 offset:44032
    v_mfma_f32_16x16x32_bf16 v[100:103], v[20:23], v[128:131], v[100:103]
    buffer_load_dwordx4 v[120:123], v159, s[8:11], s62 offen offset:1024 sc1
    v_mfma_f32_16x16x32_bf16 v[84:87], v[24:27], v[124:127], v[84:87]
    ds_read_b128 v[64:67], v150 offset:45056
    v_mfma_f32_16x16x32_bf16 v[104:107], v[24:27], v[128:131], v[104:107]
    s_waitcnt vmcnt(4) lgkmcnt(5)
    v_mfma_f32_16x16x32_bf16 v[68:71], v[28:31], v[132:135], v[68:71]
    ds_read_b128 v[8:11], v150 offset:46080
    v_mfma_f32_16x16x32_bf16 v[88:91], v[28:31], v[136:139], v[88:91]
    v_mfma_f32_16x16x32_bf16 v[72:75], v[32:35], v[132:135], v[72:75]
    ds_read_b128 v[12:15], v150 offset:47104
    v_mfma_f32_16x16x32_bf16 v[92:95], v[32:35], v[136:139], v[92:95]
    v_mfma_f32_16x16x32_bf16 v[76:79], v[36:39], v[132:135], v[76:79]
    ds_read_b128 v[16:19], v150 offset:48128
    v_mfma_f32_16x16x32_bf16 v[96:99], v[36:39], v[136:139], v[96:99]
    v_mfma_f32_16x16x32_bf16 v[80:83], v[40:43], v[132:135], v[80:83]
    ds_read_b128 v[20:23], v150 offset:49152
    v_mfma_f32_16x16x32_bf16 v[100:103], v[40:43], v[136:139], v[100:103]
    v_mfma_f32_16x16x32_bf16 v[84:87], v[44:47], v[132:135], v[84:87]
    ds_read_b128 v[24:27], v150 offset:50176
    v_mfma_f32_16x16x32_bf16 v[104:107], v[44:47], v[136:139], v[104:107]
    s_waitcnt vmcnt(0) lgkmcnt(0)
    v_mfma_f32_16x16x32_bf16 v[88:91], v[48:51], v[112:115], v[88:91]
    v_mfma_f32_16x16x32_bf16 v[88:91], v[8:11], v[120:123], v[88:91]
    v_mfma_f32_16x16x32_bf16 v[92:95], v[52:55], v[112:115], v[92:95]
    v_mfma_f32_16x16x32_bf16 v[92:95], v[12:15], v[120:123], v[92:95]
    v_mfma_f32_16x16x32_bf16 v[96:99], v[56:59], v[112:115], v[96:99]
    v_mfma_f32_16x16x32_bf16 v[96:99], v[16:19], v[120:123], v[96:99]
    v_mfma_f32_16x16x32_bf16 v[100:103], v[60:63], v[112:115], v[100:103]
    v_mfma_f32_16x16x32_bf16 v[100:103], v[20:23], v[120:123], v[100:103]
    v_mfma_f32_16x16x32_bf16 v[104:107], v[64:67], v[112:115], v[104:107]
    v_mfma_f32_16x16x32_bf16 v[104:107], v[24:27], v[120:123], v[104:107]
    v_mfma_f32_16x16x32_bf16 v[68:71], v[48:51], v[108:111], v[68:71]
    v_mfma_f32_16x16x32_bf16 v[68:71], v[8:11], v[116:119], v[68:71]
    ds_write_b128 v2, v[88:91] offset:0
    v_mfma_f32_16x16x32_bf16 v[72:75], v[52:55], v[108:111], v[72:75]
    v_mfma_f32_16x16x32_bf16 v[72:75], v[12:15], v[116:119], v[72:75]
    ds_write_b128 v2, v[92:95] offset:1024
    v_mfma_f32_16x16x32_bf16 v[76:79], v[56:59], v[108:111], v[76:79]
    v_mfma_f32_16x16x32_bf16 v[76:79], v[16:19], v[116:119], v[76:79]
    ds_write_b128 v2, v[96:99] offset:2048
    v_mfma_f32_16x16x32_bf16 v[80:83], v[60:63], v[108:111], v[80:83]
    v_mfma_f32_16x16x32_bf16 v[80:83], v[20:23], v[116:119], v[80:83]
    ds_write_b128 v2, v[100:103] offset:3072
    v_mfma_f32_16x16x32_bf16 v[84:87], v[64:67], v[108:111], v[84:87]
    v_mfma_f32_16x16x32_bf16 v[84:87], v[24:27], v[116:119], v[84:87]
    ds_write_b128 v2, v[104:107] offset:4096
    v_lshlrev_b32 v4, 16, v140
    v_and_b32 v5, 0xffff0000, v140
    v_add_f32 v68, v68, v4
    v_add_f32 v69, v69, v5
    v_lshlrev_b32 v4, 16, v141
    v_and_b32 v5, 0xffff0000, v141
    v_add_f32 v70, v70, v4
    v_add_f32 v71, v71, v5
    v_lshlrev_b32 v4, 16, v142
    v_and_b32 v5, 0xffff0000, v142
    v_add_f32 v72, v72, v4
    v_add_f32 v73, v73, v5
    v_lshlrev_b32 v4, 16, v143
    v_and_b32 v5, 0xffff0000, v143
    v_add_f32 v74, v74, v4
    v_add_f32 v75, v75, v5
    v_lshlrev_b32 v4, 16, v144
    v_and_b32 v5, 0xffff0000, v144
    v_add_f32 v76, v76, v4
    v_add_f32 v77, v77, v5
    v_lshlrev_b32 v4, 16, v145
    v_and_b32 v5, 0xffff0000, v145
    v_add_f32 v78, v78, v4
    v_add_f32 v79, v79, v5
    v_lshlrev_b32 v4, 16, v146
    v_and_b32 v5, 0xffff0000, v146
    v_add_f32 v80, v80, v4
    v_add_f32 v81, v81, v5
    v_lshlrev_b32 v4, 16, v147
    v_and_b32 v5, 0xffff0000, v147
    v_add_f32 v82, v82, v4
    v_add_f32 v83, v83, v5
    v_lshlrev_b32 v4, 16, v148
    v_and_b32 v5, 0xffff0000, v148
    v_add_f32 v84, v84, v4
    v_add_f32 v85, v85, v5
    v_lshlrev_b32 v4, 16, v149
    v_and_b32 v5, 0xffff0000, v149
    v_add_f32 v86, v86, v4
    v_add_f32 v87, v87, v5
    s_mul_i32 s62, s29, 40960
    s_mul_i32 s17, s57, 5120
    s_add_u32 s62, s62, s17
    s_lshl_b32 s17, s27, 8
    s_add_u32 s62, s62, s17
    s_add_u32 s62, s62, 10485760
    s_add_u32 s63, s62, 4096
    s_lshl3_add_u32 s60, s29, s57
    s_lshl_b32 s60, s60, 8
    s_lshl_b32 s18, s27, 6
    s_add_u32 s60, s60, s18
    s_add_u32 s60, s60, 19660800
    s_waitcnt lgkmcnt(0)
    s_barrier
    ds_read_b128 v[48:51], v3 offset:0
    ds_read_b128 v[52:55], v3 offset:1024
    ds_read_b128 v[56:59], v3 offset:2048
    ds_read_b128 v[60:63], v3 offset:3072
    ds_read_b128 v[64:67], v3 offset:4096
    s_waitcnt lgkmcnt(4)
    v_pk_add_f32 v[68:69], v[68:69], v[48:49]
    v_pk_add_f32 v[70:71], v[70:71], v[50:51]
    v_cvt_pk_bf16_f32 v108, v68, v69
    v_cvt_pk_bf16_f32 v109, v70, v71
    v_pk_add_f32 v[28:29], v[68:69], v[70:71]
    v_pk_mul_f32 v[30:31], v[68:69], v[68:69]
    v_pk_fma_f32 v[30:31], v[70:71], v[70:71], v[30:31]
    s_waitcnt lgkmcnt(3)
    v_pk_add_f32 v[72:73], v[72:73], v[52:53]
    v_pk_add_f32 v[74:75], v[74:75], v[54:55]
    v_cvt_pk_bf16_f32 v110, v72, v73
    v_cvt_pk_bf16_f32 v111, v74, v75
    v_pk_add_f32 v[28:29], v[28:29], v[72:73]
    v_pk_fma_f32 v[30:31], v[72:73], v[72:73], v[30:31]
    v_permlane32_swap_b32 v108, v110
    v_permlane32_swap_b32 v109, v111
    s_cmp_eq_u32 s6, 0
    s_cbranch_scc1 F_st3
    buffer_store_dwordx4 v[108:111], v157, s[8:11], s62 offen offset:0 nt
F_sb3:
    v_pk_add_f32 v[28:29], v[28:29], v[74:75]
    v_pk_fma_f32 v[30:31], v[74:75], v[74:75], v[30:31]
    s_waitcnt lgkmcnt(2)
    v_pk_add_f32 v[76:77], v[76:77], v[56:57]
    v_pk_add_f32 v[78:79], v[78:79], v[58:59]
    v_cvt_pk_bf16_f32 v112, v76, v77
    v_cvt_pk_bf16_f32 v113, v78, v79
    v_pk_add_f32 v[28:29], v[28:29], v[76:77]
    v_pk_fma_f32 v[30:31], v[76:77], v[76:77], v[30:31]
    v_pk_add_f32 v[28:29], v[28:29], v[78:79]
    v_pk_fma_f32 v[30:31], v[78:79], v[78:79], v[30:31]
    s_waitcnt lgkmcnt(1)
    v_pk_add_f32 v[80:81], v[80:81], v[60:61]
    v_pk_add_f32 v[82:83], v[82:83], v[62:63]
    v_cvt_pk_bf16_f32 v114, v80, v81
    v_cvt_pk_bf16_f32 v115, v82, v83
    v_pk_add_f32 v[28:29], v[28:29], v[80:81]
    v_pk_fma_f32 v[30:31], v[80:81], v[80:81], v[30:31]
    v_permlane32_swap_b32 v112, v114
    v_permlane32_swap_b32 v113, v115
    s_cmp_eq_u32 s6, 0
    s_cbranch_scc1 F_st4
    buffer_store_dwordx4 v[112:115], v157, s[8:11], s62 offen offset:2048 nt
F_sb4:
    v_pk_add_f32 v[28:29], v[28:29], v[82:83]
    v_pk_fma_f32 v[30:31], v[82:83], v[82:83], v[30:31]
    s_waitcnt lgkmcnt(0)
    v_pk_add_f32 v[84:85], v[84:85], v[64:65]
    v_pk_add_f32 v[86:87], v[86:87], v[66:67]
    v_cvt_pk_bf16_f32 v116, v84, v85
    v_cvt_pk_bf16_f32 v117, v86, v87
    v_pk_add_f32 v[28:29], v[28:29], v[84:85]
    v_pk_fma_f32 v[30:31], v[84:85], v[84:85], v[30:31]
    v_pk_add_f32 v[28:29], v[28:29], v[86:87]
    v_pk_fma_f32 v[30:31], v[86:87], v[86:87], v[30:31]
    v_add_f32 v28, v28, v29
    v_add_f32 v30, v30, v31
    s_cmp_eq_u32 s6, 0
    s_cbranch_scc1 F_st5
    buffer_store_dwordx2 v[116:117], v156, s[8:11], s63 offen
F_sb5:
    v_and_b32 v2, 0x2f, v1
    v_lshlrev_b32 v2, 2, v2
    v_permlane32_swap_b32 v28, v30
    v_add_f32 v28, v28, v30
    v_mov_b32 v30, v28
    s_lshl1_add_u32 s20, s57, s27
    s_nop 0
    v_permlane16_swap_b32 v28, v30
    v_add_f32 v28, v28, v30
    s_mov_b32 exec_lo, 0xffff
    s_mov_b32 exec_hi, 0xffff
    s_cmp_eq_u32 s6, 0
    s_cbranch_scc1 F_st6
    buffer_store_dword v28, v2, s[8:11], s60 offen
F_sb6:
    s_mov_b64 exec, -1
    s_lshl_b32 s17, s29, 7
    s_lshl2_add_u32 s17, s20, s17
    s_add_u32 s17, s17, 19472384
    v_mov_b32 v2, 0
    v_mov_b32 v3, 1
    s_mov_b64 exec, 1
    s_waitcnt vmcnt(0)
    s_cmp_eq_u32 s6, 0
    s_cbranch_scc1 F_st7
    buffer_store_dword v3, v2, s[8:11], s17 offen
F_sb7:
    s_mov_b64 exec, -1
    s_lshl2_add_u32 s64, s58, s13
    s_lshl_b32 s61, s64, 7
    s_add_u32 s61, s61, 19472384
    v_and_b32 v4, 15, v1
    v_lshlrev_b32 v4, 2, v4
    s_mov_b32 s19, 65536
    buffer_load_dword v5, v4, s[8:11], s61 offen sc1
    v_add_u32 v158, s30, v7
    v_add_u32 v159, 49152, v158
    ds_write_b128 v158, v[184:187] offset:24576
    ds_write_b128 v158, v[188:191] offset:28672
    ds_write_b128 v158, v[192:195] offset:32768
    ds_write_b128 v158, v[196:199] offset:36864
    ds_write_b128 v158, v[200:203] offset:40960
    ds_write_b128 v158, v[204:207] offset:45056
    v_mov_b32 v150, v7
    v_add_u32 v151, 61440, v150
    s_mul_i32 s21, s64, 40960
    s_add_u32 s21, s21, 10485760
    s_add_u32 s24, s21, 40960
    s_sub_u32 s17, s59, 10
    s_min_u32 s17, s17, s59
    s_mul_i32 s17, s17, 4096
    s_add_u32 s62, s21, s17
    s_lshl_b32 s63, s64, 11
    s_add_u32 s63, s63, 19660800
    s_mul_i32 s60, s59, 1536
    s_add_u32 s60, s60, 19398656
    s_waitcnt lgkmcnt(0)
    ds_read_b128 v[8:11], v150 offset:0
    ds_read_b128 v[12:15], v150 offset:1024
    ds_read_b128 v[16:19], v150 offset:2048
    ds_read_b128 v[20:23], v150 offset:3072
    ds_read_b128 v[24:27], v150 offset:4096
    ds_read_b128 v[28:31], v150 offset:5120
F_polld:
    s_waitcnt vmcnt(0)
    v_cmp_ne_u32 vcc, 1, v5
    s_cbranch_vccz F_pollxd
    buffer_load_dword v5, v4, s[8:11], s61 offen sc1
    s_sub_u32 s19, s19, 1
    s_cbranch_scc0 F_polld
F_pollxd:
    buffer_load_dwordx4 v[160:163], v7, s[8:11], s62 offen offset:0 sc1
    buffer_load_dwordx4 v[164:167], v7, s[8:11], s62 offen offset:1024 sc1
    buffer_load_dwordx4 v[168:171], v7, s[8:11], s62 offen offset:2048 sc1
    buffer_load_dwordx4 v[172:175], v7, s[8:11], s62 offen offset:3072 sc1
    s_add_u32 s62, s62, 4096
    s_cmp_eq_u32 s62, s24
    s_cselect_b32 s62, s21, s62
    buffer_load_dwordx4 v[176:179], v7, s[8:11], s62 offen offset:0 sc1
    buffer_load_dwordx4 v[180:183], v7, s[8:11], s62 offen offset:1024 sc1
    buffer_load_dwordx4 v[184:187], v7, s[8:11], s62 offen offset:2048 sc1
    buffer_load_dwordx4 v[188:191], v7, s[8:11], s62 offen offset:3072 sc1
    s_add_u32 s62, s62, 4096
    s_cmp_eq_u32 s62, s24
    s_cselect_b32 s62, s21, s62
    buffer_load_dwordx4 v[192:195], v7, s[8:11], s62 offen offset:0 sc1
    buffer_load_dwordx4 v[196:199], v7, s[8:11], s62 offen offset:1024 sc1
    v_lshlrev_b32 v5, 2, v1
    v_and_b32 v4, 0x1ff, v7
    v_lshrrev_b32 v2, 4, v1
    v_lshlrev_b32 v2, 3, v2
    s_mul_i32 s61, s57, 160
    s_waitcnt vmcnt(9) lgkmcnt(3)
    v_mfma_f32_32x32x16_bf16 v[88:103], v[8:11], v[160:163], 0
    ds_read_b128 v[32:35], v150 offset:6144
    buffer_load_dwordx4 v[200:203], v7, s[8:11], s62 offen offset:2048 sc1
    v_mfma_f32_32x32x16_bf16 v[104:119], v[12:15], v[160:163], 0
    ds_read_b128 v[36:39], v150 offset:7168
    buffer_load_dwordx4 v[204:207], v7, s[8:11], s62 offen offset:3072 sc1
    s_add_u32 s62, s62, 4096
    s_cmp_eq_u32 s62, s24
    s_cselect_b32 s62, s21, s62
    v_mfma_f32_32x32x16_bf16 v[120:135], v[16:19], v[160:163], 0
    ds_read_b128 v[40:43], v150 offset:8192
    ds_write_b128 v159, v[208:211] offset:0
    s_waitcnt vmcnt(10) lgkmcnt(4)
    v_mfma_f32_32x32x16_bf16 v[88:103], v[20:23], v[164:167], v[88:103]
    ds_read_b128 v[8:11], v150 offset:9216
    buffer_load_dwordx4 v[160:163], v7, s[8:11], s62 offen offset:0 sc1
    v_mfma_f32_32x32x16_bf16 v[104:119], v[24:27], v[164:167], v[104:119]
    ds_read_b128 v[12:15], v150 offset:10240
    v_mfma_f32_32x32x16_bf16 v[120:135], v[28:31], v[164:167], v[120:135]
    ds_read_b128 v[16:19], v150 offset:11264
    ds_write_b128 v159, v[212:215] offset:4096
    s_waitcnt vmcnt(10) lgkmcnt(5)
    v_mfma_f32_32x32x16_bf16 v[88:103], v[32:35], v[168:171], v[88:103]
    ds_read_b128 v[20:23], v150 offset:12288
    buffer_load_dwordx4 v[164:167], v7, s[8:11], s62 offen offset:1024 sc1
    ds_write_b128 v159, v[216:219] offset:8192
    v_mfma_f32_32x32x16_bf16 v[104:119], v[36:39], v[168:171], v[104:119]
    ds_read_b128 v[24:27], v150 offset:13312
    v_mfma_f32_32x32x16_bf16 v[120:135], v[40:43], v[168:171], v[120:135]
    ds_read_b128 v[28:31], v150 offset:14336
    ds_write_b128 v159, v[220:223] offset:12288
    s_waitcnt vmcnt(10) lgkmcnt(6)
    v_mfma_f32_32x32x16_bf16 v[88:103], v[8:11], v[172:175], v[88:103]
    ds_read_b128 v[32:35], v150 offset:15360
    buffer_load_dwordx4 v[168:171], v7, s[8:11], s62 offen offset:2048 sc1
    v_mfma_f32_32x32x16_bf16 v[104:119], v[12:15], v[172:175], v[104:119]
    ds_read_b128 v[36:39], v150 offset:16384
    v_mfma_f32_32x32x16_bf16 v[120:135], v[16:19], v[172:175], v[120:135]
    ds_read_b128 v[40:43], v150 offset:17408
    ds_write_b128 v159, v[224:227] offset:16384
    s_barrier
    s_waitcnt vmcnt(10) lgkmcnt(5)
    v_mfma_f32_32x32x16_bf16 v[88:103], v[20:23], v[176:179], v[88:103]
    ds_read_b128 v[8:11], v150 offset:18432
    buffer_load_dwordx4 v[172:175], v7, s[8:11], s62 offen offset:3072 sc1
    s_add_u32 s62, s62, 4096
    s_cmp_eq_u32 s62, s24
    s_cselect_b32 s62, s21, s62
    v_mfma_f32_32x32x16_bf16 v[104:119], v[24:27], v[176:179], v[104:119]
    ds_read_b128 v[12:15], v150 offset:19456
    v_mfma_f32_32x32x16_bf16 v[120:135], v[28:31], v[176:179], v[120:135]
    ds_read_b128 v[16:19], v150 offset:20480
    ds_write_b128 v159, v[228:231] offset:20480
    s_waitcnt vmcnt(10) lgkmcnt(5)
    v_mfma_f32_32x32x16_bf16 v[88:103], v[32:35], v[180:183], v[88:103]
    ds_read_b128 v[20:23], v150 offset:21504
    buffer_load_dwordx4 v[176:179], v7, s[8:11], s62 offen offset:0 sc1
    v_mfma_f32_32x32x16_bf16 v[104:119], v[36:39], v[180:183], v[104:119]
    ds_read_b128 v[24:27], v150 offset:22528
    buffer_load_dwordx2 v[140:141], v2, s[52:55], s61 offen offset:0
    v_mfma_f32_32x32x16_bf16 v[120:135], v[40:43], v[180:183], v[120:135]
    ds_read_b128 v[28:31], v150 offset:23552
    ds_write_b128 v159, v[232:235] offset:24576
    s_waitcnt vmcnt(11) lgkmcnt(5)
    v_mfma_f32_32x32x16_bf16 v[88:103], v[8:11], v[184:187], v[88:103]
    ds_read_b128 v[32:35], v150 offset:24576
    buffer_load_dwordx4 v[180:183], v7, s[8:11], s62 offen offset:1024 sc1
    ds_write_b128 v159, v[236:239] offset:28672
    v_mfma_f32_32x32x16_bf16 v[104:119], v[12:15], v[184:187], v[104:119]
    ds_read_b128 v[36:39], v150 offset:25600
    buffer_load_dwordx2 v[142:143], v2, s[52:55], s61 offen offset:32
    v_mfma_f32_32x32x16_bf16 v[120:135], v[16:19], v[184:187], v[120:135]
    ds_read_b128 v[40:43], v150 offset:26624
    ds_write_b128 v159, v[240:243] offset:32768
    s_waitcnt vmcnt(12) lgkmcnt(6)
    v_mfma_f32_32x32x16_bf16 v[88:103], v[20:23], v[188:191], v[88:103]
    ds_read_b128 v[8:11], v150 offset:27648
    buffer_load_dwordx4 v[184:187], v7, s[8:11], s62 offen offset:2048 sc1
    v_mfma_f32_32x32x16_bf16 v[104:119], v[24:27], v[188:191], v[104:119]
    ds_read_b128 v[12:15], v150 offset:28672
    buffer_load_dwordx2 v[144:145], v2, s[52:55], s61 offen offset:64
    v_mfma_f32_32x32x16_bf16 v[120:135], v[28:31], v[188:191], v[120:135]
    ds_read_b128 v[16:19], v150 offset:29696
    ds_write_b128 v159, v[244:247] offset:36864
    s_waitcnt vmcnt(13) lgkmcnt(5)
    v_mfma_f32_32x32x16_bf16 v[88:103], v[32:35], v[192:195], v[88:103]
    ds_read_b128 v[20:23], v150 offset:30720
    buffer_load_dwordx4 v[188:191], v7, s[8:11], s62 offen offset:3072 sc1
    s_add_u32 s62, s62, 4096
    s_cmp_eq_u32 s62, s24
    s_cselect_b32 s62, s21, s62
    v_mfma_f32_32x32x16_bf16 v[104:119], v[36:39], v[192:195], v[104:119]
    ds_read_b128 v[24:27], v150 offset:31744
    buffer_load_dwordx2 v[146:147], v2, s[52:55], s61 offen offset:96
    v_mfma_f32_32x32x16_bf16 v[120:135], v[40:43], v[192:195], v[120:135]
    ds_read_b128 v[28:31], v150 offset:32768
    ds_write_b128 v159, v[248:251] offset:40960
    s_waitcnt vmcnt(14) lgkmcnt(5)
    v_mfma_f32_32x32x16_bf16 v[88:103], v[8:11], v[196:199], v[88:103]
    ds_read_b128 v[32:35], v150 offset:33792
    buffer_load_dwordx4 v[192:195], v7, s[8:11], s62 offen offset:0 sc1
    v_mfma_f32_32x32x16_bf16 v[104:119], v[12:15], v[196:199], v[104:119]
    ds_read_b128 v[36:39], v150 offset:34816
    buffer_load_dwordx2 v[148:149], v2, s[52:55], s61 offen offset:128
    v_mfma_f32_32x32x16_bf16 v[120:135], v[16:19], v[196:199], v[120:135]
    ds_read_b128 v[40:43], v150 offset:35840
    ds_write_b128 v159, v[252:255] offset:45056
    s_waitcnt vmcnt(15) lgkmcnt(5)
    v_mfma_f32_32x32x16_bf16 v[88:103], v[20:23], v[200:203], v[88:103]
    ds_read_b128 v[8:11], v150 offset:36864
    buffer_load_dwordx4 v[196:199], v7, s[8:11], s62 offen offset:1024 sc1
    v_mfma_f32_32x32x16_bf16 v[104:119], v[24:27], v[200:203], v[104:119]
    ds_read_b128 v[12:15], v150 offset:37888
    v_mfma_f32_32x32x16_bf16 v[120:135], v[28:31], v[200:203], v[120:135]
    ds_read_b128 v[16:19], v150 offset:38912
    buffer_load_dword v44, v5, s[8:11], s63 offen offset:0 sc1
    s_waitcnt vmcnt(16) lgkmcnt(4)
    v_mfma_f32_32x32x16_bf16 v[88:103], v[32:35], v[204:207], v[88:103]
    ds_read_b128 v[20:23], v150 offset:39936
    buffer_load_dwordx4 v[200:203], v7, s[8:11], s62 offen offset:2048 sc1
    v_mfma_f32_32x32x16_bf16 v[104:119], v[36:39], v[204:207], v[104:119]
    ds_read_b128 v[24:27], v150 offset:40960
    v_mfma_f32_32x32x16_bf16 v[120:135], v[40:43], v[204:207], v[120:135]
    ds_read_b128 v[28:31], v150 offset:41984
    buffer_load_dword v45, v5, s[8:11], s63 offen offset:256 sc1
    s_waitcnt vmcnt(17) lgkmcnt(3)
    v_mfma_f32_32x32x16_bf16 v[88:103], v[8:11], v[160:163], v[88:103]
    ds_read_b128 v[32:35], v150 offset:43008
    buffer_load_dwordx4 v[204:207], v7, s[8:11], s62 offen offset:3072 sc1
    s_add_u32 s62, s62, 4096
    s_cmp_eq_u32 s62, s24
    s_cselect_b32 s62, s21, s62
    v_mfma_f32_32x32x16_bf16 v[104:119], v[12:15], v[160:163], v[104:119]
    ds_read_b128 v[36:39], v150 offset:44032
    v_mfma_f32_32x32x16_bf16 v[120:135], v[16:19], v[160:163], v[120:135]
    ds_read_b128 v[40:43], v150 offset:45056
    buffer_load_dword v46, v5, s[8:11], s63 offen offset:512 sc1
    s_barrier
    s_waitcnt vmcnt(18) lgkmcnt(3)
    v_mfma_f32_32x32x16_bf16 v[88:103], v[20:23], v[164:167], v[88:103]
    ds_read_b128 v[8:11], v150 offset:46080
    buffer_load_dwordx4 v[160:163], v7, s[8:11], s62 offen offset:0 sc1
    v_mfma_f32_32x32x16_bf16 v[104:119], v[24:27], v[164:167], v[104:119]
    ds_read_b128 v[12:15], v150 offset:47104
    v_mfma_f32_32x32x16_bf16 v[120:135], v[28:31], v[164:167], v[120:135]
    ds_read_b128 v[16:19], v150 offset:48128
    buffer_load_dword v47, v5, s[8:11], s63 offen offset:768 sc1
    s_waitcnt vmcnt(19) lgkmcnt(3)
    v_mfma_f32_32x32x16_bf16 v[88:103], v[32:35], v[168:171], v[88:103]
    ds_read_b128 v[20:23], v150 offset:49152
    buffer_load_dwordx4 v[164:167], v7, s[8:11], s62 offen offset:1024 sc1
    v_mfma_f32_32x32x16_bf16 v[104:119], v[36:39], v[168:171], v[104:119]
    ds_read_b128 v[24:27], v150 offset:50176
    v_mfma_f32_32x32x16_bf16 v[120:135], v[40:43], v[168:171], v[120:135]
    ds_read_b128 v[28:31], v150 offset:51200
    buffer_load_dword v48, v5, s[8:11], s63 offen offset:1024 sc1
    s_waitcnt vmcnt(20) lgkmcnt(3)
    v_mfma_f32_32x32x16_bf16 v[88:103], v[8:11], v[172:175], v[88:103]
    ds_read_b128 v[32:35], v150 offset:52224
    buffer_load_dwordx4 v[168:171], v7, s[8:11], s62 offen offset:2048 sc1
    v_mfma_f32_32x32x16_bf16 v[104:119], v[12:15], v[172:175], v[104:119]
    ds_read_b128 v[36:39], v150 offset:53248
    v_mfma_f32_32x32x16_bf16 v[120:135], v[16:19], v[172:175], v[120:135]
    ds_read_b128 v[40:43], v150 offset:54272
    buffer_load_dword v49, v5, s[8:11], s63 offen offset:1280 sc1
    s_waitcnt vmcnt(21) lgkmcnt(3)
    v_mfma_f32_32x32x16_bf16 v[88:103], v[20:23], v[176:179], v[88:103]
    ds_read_b128 v[8:11], v150 offset:55296
    buffer_load_dwordx4 v[172:175], v7, s[8:11], s62 offen offset:3072 sc1
    s_add_u32 s62, s62, 4096
    s_cmp_eq_u32 s62, s24
    s_cselect_b32 s62, s21, s62
    v_mfma_f32_32x32x16_bf16 v[104:119], v[24:27], v[176:179], v[104:119]
    ds_read_b128 v[12:15], v150 offset:56320
    v_mfma_f32_32x32x16_bf16 v[120:135], v[28:31], v[176:179], v[120:135]
    ds_read_b128 v[16:19], v150 offset:57344
    buffer_load_dword v50, v5, s[8:11], s63 offen offset:1536 sc1
    s_waitcnt vmcnt(21) lgkmcnt(3)
    v_mfma_f32_32x32x16_bf16 v[88:103], v[32:35], v[180:183], v[88:103]
    ds_read_b128 v[20:23], v150 offset:58368
    buffer_load_dwordx4 v[176:179], v7, s[8:11], s62 offen offset:0 sc1
    v_mfma_f32_32x32x16_bf16 v[104:119], v[36:39], v[180:183], v[104:119]
    ds_read_b128 v[24:27], v150 offset:59392
    v_mfma_f32_32x32x16_bf16 v[120:135], v[40:43], v[180:183], v[120:135]
    ds_read_b128 v[28:31], v150 offset:60416
    buffer_load_dword v51, v5, s[8:11], s63 offen offset:1792 sc1
    s_waitcnt vmcnt(16) lgkmcnt(3)
    v_mfma_f32_32x32x16_bf16 v[88:103], v[8:11], v[184:187], v[88:103]
    ds_read_b128 v[32:35], v151 offset:0
    buffer_load_dwordx4 v[180:183], v7, s[8:11], s62 offen offset:1024 sc1
    v_lshlrev_b32 v2, 16, v140
    v_and_b32 v3, 0xffff0000, v140
    v_mfma_f32_32x32x16_bf16 v[104:119], v[12:15], v[184:187], v[104:119]
    ds_read_b128 v[36:39], v151 offset:1024
    v_add_f32 v232, v68, v2
    v_add_f32 v233, v69, v3
    v_mfma_f32_32x32x16_bf16 v[120:135], v[16:19], v[184:187], v[120:135]
    ds_read_b128 v[40:43], v151 offset:2048
    buffer_load_dwordx4 v[56:59], v4, s[8:11], s60 offen offset:0
    v_lshlrev_b32 v2, 16, v141
    v_and_b32 v3, 0xffff0000, v141
    s_waitcnt vmcnt(21) lgkmcnt(3)
    v_mfma_f32_32x32x16_bf16 v[88:103], v[20:23], v[188:191], v[88:103]
    ds_read_b128 v[8:11], v151 offset:3072
    buffer_load_dwordx4 v[184:187], v7, s[8:11], s62 offen offset:2048 sc1
    v_add_f32 v234, v70, v2
    v_add_f32 v235, v71, v3
    v_mfma_f32_32x32x16_bf16 v[104:119], v[24:27], v[188:191], v[104:119]
    ds_read_b128 v[12:15], v151 offset:4096
    v_lshlrev_b32 v2, 16, v142
    v_and_b32 v3, 0xffff0000, v142
    v_mfma_f32_32x32x16_bf16 v[120:135], v[28:31], v[188:191], v[120:135]
    ds_read_b128 v[16:19], v151 offset:5120
    buffer_load_dwordx4 v[60:63], v4, s[8:11], s60 offen offset:512
    v_add_f32 v236, v72, v2
    v_add_f32 v237, v73, v3
    s_waitcnt vmcnt(21) lgkmcnt(3)
    v_mfma_f32_32x32x16_bf16 v[88:103], v[32:35], v[192:195], v[88:103]
    ds_read_b128 v[20:23], v151 offset:6144
    buffer_load_dwordx4 v[188:191], v7, s[8:11], s62 offen offset:3072 sc1
    s_add_u32 s62, s62, 4096
    s_cmp_eq_u32 s62, s24
    s_cselect_b32 s62, s21, s62
    v_lshlrev_b32 v2, 16, v143
    v_and_b32 v3, 0xffff0000, v143
    v_mfma_f32_32x32x16_bf16 v[104:119], v[36:39], v[192:195], v[104:119]
    ds_read_b128 v[24:27], v151 offset:7168
    v_add_f32 v238, v74, v2
    v_add_f32 v239, v75, v3
    v_mfma_f32_32x32x16_bf16 v[120:135], v[40:43], v[192:195], v[120:135]
    ds_read_b128 v[28:31], v151 offset:8192
    buffer_load_dwordx4 v[64:67], v4, s[8:11], s60 offen offset:1024
    v_lshlrev_b32 v2, 16, v144
    v_and_b32 v3, 0xffff0000, v144
    s_barrier
    s_waitcnt vmcnt(21) lgkmcnt(3)
    v_mfma_f32_32x32x16_bf16 v[88:103], v[8:11], v[196:199], v[88:103]
    ds_read_b128 v[32:35], v151 offset:9216
    buffer_load_dwordx4 v[192:195], v7, s[8:11], s62 offen offset:0 sc1
    v_add_f32 v240, v76, v2
    v_add_f32 v241, v77, v3
    v_mfma_f32_32x32x16_bf16 v[104:119], v[12:15], v[196:199], v[104:119]
    ds_read_b128 v[36:39], v151 offset:10240
    v_lshlrev_b32 v2, 16, v145
    v_and_b32 v3, 0xffff0000, v145
    v_mfma_f32_32x32x16_bf16 v[120:135], v[16:19], v[196:199], v[120:135]
    ds_read_b128 v[40:43], v151 offset:11264
    v_add_f32 v242, v78, v2
    v_add_f32 v243, v79, v3
    s_waitcnt vmcnt(20) lgkmcnt(3)
    v_mfma_f32_32x32x16_bf16 v[88:103], v[20:23], v[200:203], v[88:103]
    ds_read_b128 v[8:11], v151 offset:12288
    buffer_load_dwordx4 v[196:199], v7, s[8:11], s62 offen offset:1024 sc1
    v_lshlrev_b32 v2, 16, v146
    v_and_b32 v3, 0xffff0000, v146
    v_mfma_f32_32x32x16_bf16 v[104:119], v[24:27], v[200:203], v[104:119]
    ds_read_b128 v[12:15], v151 offset:13312
    v_add_f32 v244, v80, v2
    v_add_f32 v245, v81, v3
    v_mfma_f32_32x32x16_bf16 v[120:135], v[28:31], v[200:203], v[120:135]
    ds_read_b128 v[16:19], v151 offset:14336
    v_lshlrev_b32 v2, 16, v147
    v_and_b32 v3, 0xffff0000, v147
    s_waitcnt vmcnt(19) lgkmcnt(3)
    v_mfma_f32_32x32x16_bf16 v[88:103], v[32:35], v[204:207], v[88:103]
    ds_read_b128 v[20:23], v151 offset:15360
    buffer_load_dwordx4 v[200:203], v7, s[8:11], s62 offen offset:2048 sc1
    v_add_f32 v246, v82, v2
    v_add_f32 v247, v83, v3
    v_mfma_f32_32x32x16_bf16 v[104:119], v[36:39], v[204:207], v[104:119]
    ds_read_b128 v[24:27], v151 offset:16384
    v_lshlrev_b32 v2, 16, v148
    v_and_b32 v3, 0xffff0000, v148
    v_mfma_f32_32x32x16_bf16 v[120:135], v[40:43], v[204:207], v[120:135]
    ds_read_b128 v[28:31], v151 offset:17408
    v_add_f32 v248, v84, v2
    v_add_f32 v249, v85, v3
    s_waitcnt vmcnt(18) lgkmcnt(3)
    v_mfma_f32_32x32x16_bf16 v[88:103], v[8:11], v[160:163], v[88:103]
    ds_read_b128 v[32:35], v151 offset:18432
    buffer_load_dwordx4 v[204:207], v7, s[8:11], s62 offen offset:3072 sc1
    s_add_u32 s62, s62, 4096
    s_cmp_eq_u32 s62, s24
    s_cselect_b32 s62, s21, s62
    v_lshlrev_b32 v2, 16, v149
    v_and_b32 v3, 0xffff0000, v149
    v_mfma_f32_32x32x16_bf16 v[104:119], v[12:15], v[160:163], v[104:119]
    ds_read_b128 v[36:39], v151 offset:19456
    v_add_f32 v250, v86, v2
    v_add_f32 v251, v87, v3
    v_mfma_f32_32x32x16_bf16 v[120:135], v[16:19], v[160:163], v[120:135]
    ds_read_b128 v[40:43], v151 offset:20480
    s_waitcnt vmcnt(10) lgkmcnt(3)
    v_mfma_f32_32x32x16_bf16 v[88:103], v[20:23], v[164:167], v[88:103]
    ds_read_b128 v[8:11], v151 offset:21504
    buffer_load_dwordx4 v[160:163], v7, s[8:11], s62 offen offset:0 sc1
    v_add_f32 v44, v44, v48
    v_add_f32 v45, v45, v49
    v_mfma_f32_32x32x16_bf16 v[104:119], v[24:27], v[164:167], v[104:119]
    ds_read_b128 v[12:15], v151 offset:22528
    v_add_f32 v46, v46, v50
    v_add_f32 v47, v47, v51
    v_mfma_f32_32x32x16_bf16 v[120:135], v[28:31], v[164:167], v[120:135]
    ds_read_b128 v[16:19], v151 offset:23552
    v_add_f32 v44, v44, v46
    v_add_f32 v45, v45, v47
    s_waitcnt vmcnt(16) lgkmcnt(3)
    v_mfma_f32_32x32x16_bf16 v[88:103], v[32:35], v[168:171], v[88:103]
    ds_read_b128 v[20:23], v151 offset:24576
    buffer_load_dwordx4 v[164:167], v7, s[8:11], s62 offen offset:1024 sc1
    v_add_f32 v44, v44, v45
    v_mov_b32 v45, v44
    v_mfma_f32_32x32x16_bf16 v[104:119], v[36:39], v[168:171], v[104:119]
    ds_read_b128 v[24:27], v151 offset:25600
    s_nop 1
    v_permlane32_swap_b32 v44, v45
    v_mfma_f32_32x32x16_bf16 v[120:135], v[40:43], v[168:171], v[120:135]
    ds_read_b128 v[28:31], v151 offset:26624
    v_mul_f32 v44, 0xbacccccd, v44
    v_mul_f32 v45, 0x3acccccd, v45
    s_waitcnt vmcnt(15) lgkmcnt(3)
    v_mfma_f32_32x32x16_bf16 v[88:103], v[8:11], v[172:175], v[88:103]
    ds_read_b128 v[32:35], v151 offset:27648
    buffer_load_dwordx4 v[168:171], v7, s[8:11], s62 offen offset:2048 sc1
    v_fma_f32 v45, -v44, v44, v45
    v_max_f32 v45, 0, v45
    v_mfma_f32_32x32x16_bf16 v[104:119], v[12:15], v[172:175], v[104:119]
    ds_read_b128 v[36:39], v151 offset:28672
    v_add_f32 v45, 0x3727c5ac, v45
    v_sqrt_f32 v47, v45
    v_mfma_f32_32x32x16_bf16 v[120:135], v[16:19], v[172:175], v[120:135]
    ds_read_b128 v[40:43], v151 offset:29696
    v_rcp_f32 v46, v45
    v_cndmask_b32 v44, 0, v44, s[40:41]
    s_waitcnt vmcnt(14) lgkmcnt(3)
    v_mfma_f32_32x32x16_bf16 v[88:103], v[20:23], v[176:179], v[88:103]
    ds_read_b128 v[8:11], v151 offset:30720
    buffer_load_dwordx4 v[172:175], v7, s[8:11], s62 offen offset:3072 sc1
    v_cndmask_b32 v47, 0, v47, s[40:41]
    v_cvt_pk_bf16_f32 v53, v44, v47
    v_mfma_f32_32x32x16_bf16 v[104:119], v[24:27], v[176:179], v[104:119]
    ds_read_b128 v[12:15], v151 offset:31744
    v_lshlrev_b32 v2, 16, v53
    v_and_b32 v3, 0xffff0000, v53
    v_mfma_f32_32x32x16_bf16 v[120:135], v[28:31], v[176:179], v[120:135]
    ds_read_b128 v[16:19], v151 offset:32768
    v_sub_f32 v2, v44, v2
    v_sub_f32 v3, v47, v3
    s_waitcnt vmcnt(13) lgkmcnt(3)
    v_mfma_f32_32x32x16_bf16 v[88:103], v[32:35], v[180:183], v[88:103]
    ds_read_b128 v[20:23], v151 offset:33792
    v_cvt_pk_bf16_f32 v52, v44, v2
    v_cvt_pk_bf16_f32 v54, v3, 0
    v_mfma_f32_32x32x16_bf16 v[104:119], v[36:39], v[180:183], v[104:119]
    ds_read_b128 v[24:27], v151 offset:34816
    v_mov_b32 v55, 0
    v_bfe_u32 v2, v1, 4, 1
    v_mfma_f32_32x32x16_bf16 v[120:135], v[40:43], v[180:183], v[120:135]
    ds_read_b128 v[28:31], v151 offset:35840
    v_mul_u32_u24 v2, 49152, v2
    v_lshl_add_u32 v2, v6, 8, v2
    s_barrier
    s_waitcnt vmcnt(11) lgkmcnt(3)
    v_mfma_f32_32x32x16_bf16 v[88:103], v[8:11], v[184:187], v[88:103]
    ds_read_b128 v[32:35], v151 offset:36864
    v_and_b32 v3, 15, v1
    v_lshl_add_u32 v4, v3, 4, v2
    v_mfma_f32_32x32x16_bf16 v[104:119], v[12:15], v[184:187], v[104:119]
    ds_read_b128 v[36:39], v151 offset:39936
    s_mul_i32 s19, s64, 98304
    s_mul_i32 s18, s59, 3072
    v_mfma_f32_32x32x16_bf16 v[120:135], v[16:19], v[184:187], v[120:135]
    ds_read_b128 v[40:43], v151 offset:43008
    s_add_u32 s19, s19, s18
    s_add_u32 s19, s19, 13107200
    s_waitcnt vmcnt(9) lgkmcnt(3)
    v_mfma_f32_32x32x16_bf16 v[88:103], v[20:23], v[188:191], v[88:103]
    ds_read_b128 v[8:11], v151 offset:46080
    v_mfma_f32_32x32x16_bf16 v[104:119], v[24:27], v[188:191], v[104:119]
    ds_read_b128 v[12:15], v151 offset:49152
    v_mfma_f32_32x32x16_bf16 v[120:135], v[28:31], v[188:191], v[120:135]
    ds_read_b128 v[16:19], v151 offset:52224
    s_waitcnt vmcnt(0) lgkmcnt(3)
    v_mfma_f32_32x32x16_bf16 v[88:103], v[32:35], v[192:195], v[88:103]
    ds_read_b128 v[20:23], v151 offset:55296
    s_and_b32 s17, s59, 7
    s_cbranch_scc1 F_nor2
    s_lshl3_add_u32 s17, s59, s64
    s_lshl_b32 s17, s17, 7
    s_add_u32 s17, s17, 19857408
    s_mov_b32 exec_hi, 0
    s_cmp_eq_u32 s6, 0
    s_cbranch_scc1 F_st8
    buffer_store_dword v46, v5, s[8:11], s17 offen
F_sb8:
    s_mov_b32 exec_hi, -1
F_nor2:
    v_mfma_f32_32x32x16_bf16 v[88:103], v[36:39], v[196:199], v[88:103]
    ds_read_b128 v[24:27], v151 offset:58368
    v_mfma_f32_32x32x16_bf16 v[88:103], v[40:43], v[200:203], v[88:103]
    ds_read_b128 v[28:31], v151 offset:37888
    s_waitcnt vmcnt(63) lgkmcnt(3)
    v_mfma_f32_32x32x16_bf16 v[88:103], v[8:11], v[204:207], v[88:103]
    ds_read_b128 v[32:35], v151 offset:40960
    v_mfma_f32_32x32x16_bf16 v[88:103], v[12:15], v[160:163], v[88:103]
    ds_read_b128 v[36:39], v151 offset:44032
    v_mfma_f32_32x32x16_bf16 v[88:103], v[16:19], v[164:167], v[88:103]
    ds_read_b128 v[40:43], v151 offset:47104
    s_waitcnt vmcnt(63) lgkmcnt(4)
    v_mfma_f32_32x32x16_bf16 v[88:103], v[20:23], v[168:171], v[88:103]
    ds_read_b128 v[8:11], v151 offset:50176
    v_mfma_f32_32x32x16_bf16 v[88:103], v[24:27], v[172:175], v[88:103]
    ds_read_b128 v[12:15], v151 offset:53248
    v_mfma_f32_32x32x16_bf16 v[88:103], v[56:59], v[52:55], v[88:103]
    s_waitcnt vmcnt(63) lgkmcnt(3)
    v_mfma_f32_32x32x16_bf16 v[104:119], v[28:31], v[192:195], v[104:119]
    ds_read_b128 v[16:19], v151 offset:56320
    v_mfma_f32_32x32x16_bf16 v[104:119], v[32:35], v[196:199], v[104:119]
    ds_read_b128 v[20:23], v151 offset:59392
    v_mfma_f32_32x32x16_bf16 v[104:119], v[36:39], v[200:203], v[104:119]
    ds_read_b128 v[24:27], v151 offset:38912
    s_nop 4
    v_max_f32 v88, 0, v88
    v_max_f32 v89, 0, v89
    v_max_f32 v90, 0, v90
    v_max_f32 v91, 0, v91
    v_max_f32 v92, 0, v92
    v_max_f32 v93, 0, v93
    s_waitcnt vmcnt(63) lgkmcnt(3)
    v_mfma_f32_32x32x16_bf16 v[104:119], v[40:43], v[204:207], v[104:119]
    ds_read_b128 v[28:31], v151 offset:41984
    v_max_f32 v94, 0, v94
    v_max_f32 v95, 0, v95
    v_mul_f32 v88, v88, v88
    v_mul_f32 v89, v89, v89
    v_mul_f32 v90, v90, v90
    v_mul_f32 v91, v91, v91
    v_mfma_f32_32x32x16_bf16 v[104:119], v[8:11], v[160:163], v[104:119]
    ds_read_b128 v[32:35], v151 offset:45056
    v_mul_f32 v92, v92, v92
    v_mul_f32 v93, v93, v93
    v_mul_f32 v94, v94, v94
    v_mul_f32 v95, v95, v95
    v_cvt_pk_bf16_f32 v208, v88, v89
    v_cvt_pk_bf16_f32 v209, v90, v91
    v_mfma_f32_32x32x16_bf16 v[104:119], v[12:15], v[164:167], v[104:119]
    ds_read_b128 v[36:39], v151 offset:48128
    v_cvt_pk_bf16_f32 v210, v92, v93
    v_cvt_pk_bf16_f32 v211, v94, v95
    s_cmp_eq_u32 s6, 0
    s_cbranch_scc1 F_st9
    buffer_store_dwordx4 v[208:211], v4, s[8:11], s19 offen offset:0 nt
F_sb9:
    v_max_f32 v96, 0, v96
    v_max_f32 v97, 0, v97
    v_max_f32 v98, 0, v98
    s_waitcnt vmcnt(63) lgkmcnt(4)
    v_mfma_f32_32x32x16_bf16 v[104:119], v[16:19], v[168:171], v[104:119]
    ds_read_b128 v[40:43], v151 offset:51200
    v_max_f32 v99, 0, v99
    v_max_f32 v100, 0, v100
    v_max_f32 v101, 0, v101
    v_max_f32 v102, 0, v102
    v_max_f32 v103, 0, v103
    v_mul_f32 v96, v96, v96
    v_mfma_f32_32x32x16_bf16 v[104:119], v[20:23], v[172:175], v[104:119]
    ds_read_b128 v[8:11], v151 offset:54272
    v_mul_f32 v97, v97, v97
    v_mul_f32 v98, v98, v98
    v_mul_f32 v99, v99, v99
    v_mul_f32 v100, v100, v100
    v_mul_f32 v101, v101, v101
    v_mul_f32 v102, v102, v102
    v_mfma_f32_32x32x16_bf16 v[104:119], v[60:63], v[52:55], v[104:119]
    v_mul_f32 v103, v103, v103
    v_cvt_pk_bf16_f32 v212, v96, v97
    v_cvt_pk_bf16_f32 v213, v98, v99
    v_cvt_pk_bf16_f32 v214, v100, v101
    v_cvt_pk_bf16_f32 v215, v102, v103
    s_cmp_eq_u32 s6, 0
    s_cbranch_scc1 F_st10
    buffer_store_dwordx4 v[212:215], v4, s[8:11], s19 offen offset:512 nt
F_sb10:
    s_waitcnt vmcnt(63) lgkmcnt(3)
    v_mfma_f32_32x32x16_bf16 v[120:135], v[24:27], v[192:195], v[120:135]
    ds_read_b128 v[12:15], v151 offset:57344
    v_mfma_f32_32x32x16_bf16 v[120:135], v[28:31], v[196:199], v[120:135]
    ds_read_b128 v[16:19], v151 offset:60416
    v_mfma_f32_32x32x16_bf16 v[120:135], v[32:35], v[200:203], v[120:135]
    v_max_f32 v104, 0, v104
    v_max_f32 v105, 0, v105
    v_max_f32 v106, 0, v106
    v_max_f32 v107, 0, v107
    v_max_f32 v108, 0, v108
    v_max_f32 v109, 0, v109
    s_waitcnt vmcnt(63) lgkmcnt(2)
    v_mfma_f32_32x32x16_bf16 v[120:135], v[36:39], v[204:207], v[120:135]
    v_max_f32 v110, 0, v110
    v_max_f32 v111, 0, v111
    v_mul_f32 v104, v104, v104
    v_mul_f32 v105, v105, v105
    v_mul_f32 v106, v106, v106
    v_mul_f32 v107, v107, v107
    v_mfma_f32_32x32x16_bf16 v[120:135], v[40:43], v[160:163], v[120:135]
    v_mul_f32 v108, v108, v108
    v_mul_f32 v109, v109, v109
    v_mul_f32 v110, v110, v110
    v_mul_f32 v111, v111, v111
    v_cvt_pk_bf16_f32 v216, v104, v105
    v_cvt_pk_bf16_f32 v217, v106, v107
    v_mfma_f32_32x32x16_bf16 v[120:135], v[8:11], v[164:167], v[120:135]
    v_cvt_pk_bf16_f32 v218, v108, v109
    v_cvt_pk_bf16_f32 v219, v110, v111
    s_cmp_eq_u32 s6, 0
    s_cbranch_scc1 F_st11
    buffer_store_dwordx4 v[216:219], v4, s[8:11], s19 offen offset:1024 nt
F_sb11:
    v_max_f32 v112, 0, v112
    v_max_f32 v113, 0, v113
    v_max_f32 v114, 0, v114
    s_waitcnt vmcnt(63) lgkmcnt(0)
    v_mfma_f32_32x32x16_bf16 v[120:135], v[12:15], v[168:171], v[120:135]
    v_max_f32 v115, 0, v115
    v_max_f32 v116, 0, v116
    v_max_f32 v117, 0, v117
    v_max_f32 v118, 0, v118
    v_max_f32 v119, 0, v119
    v_mul_f32 v112, v112, v112
    v_mfma_f32_32x32x16_bf16 v[120:135], v[16:19], v[172:175], v[120:135]
    v_mul_f32 v113, v113, v113
    v_mul_f32 v114, v114, v114
    v_mul_f32 v115, v115, v115
    v_mul_f32 v116, v116, v116
    v_mul_f32 v117, v117, v117
    v_mul_f32 v118, v118, v118
    v_mfma_f32_32x32x16_bf16 v[120:135], v[64:67], v[52:55], v[120:135]
    v_mul_f32 v119, v119, v119
    v_cvt_pk_bf16_f32 v220, v112, v113
    v_cvt_pk_bf16_f32 v221, v114, v115
    v_cvt_pk_bf16_f32 v222, v116, v117
    v_cvt_pk_bf16_f32 v223, v118, v119
    s_cmp_eq_u32 s6, 0
    s_cbranch_scc1 F_st12
    buffer_store_dwordx4 v[220:223], v4, s[8:11], s19 offen offset:1536 nt
F_sb12:
    s_barrier
    s_nop 2
    v_max_f32 v120, 0, v120
    v_max_f32 v121, 0, v121
    v_max_f32 v122, 0, v122
    v_max_f32 v123, 0, v123
    v_max_f32 v124, 0, v124
    v_max_f32 v125, 0, v125
    v_max_f32 v126, 0, v126
    v_max_f32 v127, 0, v127
    v_pk_mul_f32 v[120:121], v[120:121], v[120:121]
    v_pk_mul_f32 v[122:123], v[122:123], v[122:123]
    v_pk_mul_f32 v[124:125], v[124:125], v[124:125]
    v_pk_mul_f32 v[126:127], v[126:127], v[126:127]
    v_cvt_pk_bf16_f32 v224, v120, v121
    v_cvt_pk_bf16_f32 v225, v122, v123
    v_cvt_pk_bf16_f32 v226, v124, v125
    v_cvt_pk_bf16_f32 v227, v126, v127
    s_cmp_eq_u32 s6, 0
    s_cbranch_scc1 F_st13
    buffer_store_dwordx4 v[224:227], v4, s[8:11], s19 offen offset:2048 nt
F_sb13:
    v_max_f32 v128, 0, v128
    v_max_f32 v129, 0, v129
    v_max_f32 v130, 0, v130
    v_max_f32 v131, 0, v131
    v_max_f32 v132, 0, v132
    v_max_f32 v133, 0, v133
    v_max_f32 v134, 0, v134
    v_max_f32 v135, 0, v135
    v_pk_mul_f32 v[128:129], v[128:129], v[128:129]
    v_pk_mul_f32 v[130:131], v[130:131], v[130:131]
    v_pk_mul_f32 v[132:133], v[132:133], v[132:133]
    v_pk_mul_f32 v[134:135], v[134:135], v[134:135]
    v_cvt_pk_bf16_f32 v228, v128, v129
    v_cvt_pk_bf16_f32 v229, v130, v131
    v_cvt_pk_bf16_f32 v230, v132, v133
    v_cvt_pk_bf16_f32 v231, v134, v135
    s_cmp_eq_u32 s6, 0
    s_cbranch_scc1 F_st14
    buffer_store_dwordx4 v[228:231], v4, s[8:11], s19 offen offset:2560 nt
F_sb14:
    v_mov_b32 v151, v7
    s_lshl_b32 s17, s64, 7
    s_lshl2_add_u32 s17, s59, s17
    s_add_u32 s17, s17, 19480576
    v_mov_b32 v2, 0
    v_mov_b32 v3, 1
    s_mov_b64 exec, 1
    s_waitcnt vmcnt(0)
    s_cmp_eq_u32 s6, 0
    s_cbranch_scc1 F_st15
    buffer_store_dword v3, v2, s[8:11], s17 offen
F_sb15:
    s_mov_b64 exec, -1
    s_lshl_b32 s20, s27, 3
    s_lshl_b32 s61, s29, 7
    s_lshl2_add_u32 s61, s20, s61
    s_add_u32 s61, s61, 19480576
    v_and_b32 v4, 7, v1
    v_lshlrev_b32 v4, 2, v4
    s_mov_b32 s19, 65536
    buffer_load_dword v5, v4, s[8:11], s61 offen sc1
    s_mul_i32 s17, s27, 20480
    s_add_u32 s17, s17, 122880
    v_add_u32 v150, s17, v151
    s_mul_i32 s17, s27, 61440
    v_add_u32 v151, s17, v151
    ds_read_b128 v[8:11], v150 offset:0
    ds_read_b128 v[12:15], v150 offset:1024
    ds_read_b128 v[16:19], v150 offset:2048
    ds_read_b128 v[20:23], v150 offset:3072
    ds_read_b128 v[24:27], v150 offset:4096
    ds_read_b128 v[28:31], v150 offset:5120
    ds_read_b128 v[32:35], v150 offset:6144
    ds_read_b128 v[36:39], v150 offset:7168
    ds_read_b128 v[40:43], v150 offset:8192
    ds_read_b128 v[44:47], v150 offset:9216
    s_mul_i32 s21, s29, 98304
    s_mul_i32 s17, s27, 24576
    s_add_u32 s21, s21, s17
    s_add_u32 s21, s21, 13107200
    s_add_u32 s24, s21, 24576
    s_sub_u32 s17, s57, 6
    s_min_u32 s17, s17, s57
    s_mul_i32 s17, s17, 4096
    s_add_u32 s62, s21, s17
    s_mul_i32 s17, s27, 49152
    v_add_u32 v158, s17, v7
    s_sub_u32 s17, 49152, s17
    v_add_u32 v159, s17, v7
    s_mul_i32 s17, s13, 5120
    s_add_u32 s17, s17, 20480
    v_add_u32 v2, s17, v7
    s_xor_b32 s17, s13, 2
    s_mul_i32 s17, s17, 5120
    s_add_u32 s17, s17, 20480
    v_add_u32 v3, s17, v7
F_polle:
    s_waitcnt vmcnt(0)
    v_cmp_ne_u32 vcc, 1, v5
    s_cbranch_vccz F_pollxe
    buffer_load_dword v5, v4, s[8:11], s61 offen sc1
    s_sub_u32 s19, s19, 1
    s_cbranch_scc0 F_polle
F_pollxe:
    buffer_load_dwordx4 v[160:163], v158, s[8:11], s62 offen offset:0 sc1
    buffer_load_dwordx4 v[164:167], v159, s[8:11], s62 offen offset:0 sc1
    buffer_load_dwordx4 v[168:171], v158, s[8:11], s62 offen offset:1024 sc1
    buffer_load_dwordx4 v[172:175], v159, s[8:11], s62 offen offset:1024 sc1
    buffer_load_dwordx4 v[176:179], v158, s[8:11], s62 offen offset:2048 sc1
    buffer_load_dwordx4 v[180:183], v159, s[8:11], s62 offen offset:2048 sc1
    buffer_load_dwordx4 v[184:187], v158, s[8:11], s62 offen offset:3072 sc1
    buffer_load_dwordx4 v[188:191], v159, s[8:11], s62 offen offset:3072 sc1
    s_add_u32 s62, s62, 4096
    s_cmp_eq_u32 s62, s24
    s_cselect_b32 s62, s21, s62
    buffer_load_dwordx4 v[192:195], v158, s[8:11], s62 offen offset:0 sc1
    buffer_load_dwordx4 v[196:199], v159, s[8:11], s62 offen offset:0 sc1
    buffer_load_dwordx4 v[200:203], v158, s[8:11], s62 offen offset:1024 sc1
    buffer_load_dwordx4 v[204:207], v159, s[8:11], s62 offen offset:1024 sc1
    s_waitcnt vmcnt(10) lgkmcnt(5)
    v_mfma_f32_16x16x32_bf16 v[68:71], v[8:11], v[160:163], 0
    ds_read_b128 v[48:51], v150 offset:10240
    v_mfma_f32_16x16x32_bf16 v[88:91], v[8:11], v[164:167], 0
    v_mfma_f32_16x16x32_bf16 v[72:75], v[12:15], v[160:163], 0
    ds_read_b128 v[52:55], v150 offset:11264
    v_mfma_f32_16x16x32_bf16 v[92:95], v[12:15], v[164:167], 0
    buffer_load_dwordx4 v[208:211], v158, s[8:11], s62 offen offset:2048 sc1
    v_mfma_f32_16x16x32_bf16 v[76:79], v[16:19], v[160:163], 0
    ds_read_b128 v[56:59], v150 offset:12288
    v_mfma_f32_16x16x32_bf16 v[96:99], v[16:19], v[164:167], 0
    v_mfma_f32_16x16x32_bf16 v[80:83], v[20:23], v[160:163], 0
    ds_read_b128 v[60:63], v150 offset:13312
    v_mfma_f32_16x16x32_bf16 v[100:103], v[20:23], v[164:167], 0
    buffer_load_dwordx4 v[212:215], v159, s[8:11], s62 offen offset:2048 sc1
    v_mfma_f32_16x16x32_bf16 v[84:87], v[24:27], v[160:163], 0
    ds_read_b128 v[64:67], v150 offset:14336
    v_mfma_f32_16x16x32_bf16 v[104:107], v[24:27], v[164:167], 0
    s_waitcnt vmcnt(10) lgkmcnt(5)
    v_mfma_f32_16x16x32_bf16 v[68:71], v[28:31], v[168:171], v[68:71]
    ds_read_b128 v[8:11], v150 offset:15360
    v_mfma_f32_16x16x32_bf16 v[88:91], v[28:31], v[172:175], v[88:91]
    v_mfma_f32_16x16x32_bf16 v[72:75], v[32:35], v[168:171], v[72:75]
    ds_read_b128 v[12:15], v150 offset:16384
    v_mfma_f32_16x16x32_bf16 v[92:95], v[32:35], v[172:175], v[92:95]
    buffer_load_dwordx4 v[216:219], v158, s[8:11], s62 offen offset:3072 sc1
    v_mfma_f32_16x16x32_bf16 v[76:79], v[36:39], v[168:171], v[76:79]
    ds_read_b128 v[16:19], v150 offset:17408
    v_mfma_f32_16x16x32_bf16 v[96:99], v[36:39], v[172:175], v[96:99]
    v_mfma_f32_16x16x32_bf16 v[80:83], v[40:43], v[168:171], v[80:83]
    ds_read_b128 v[20:23], v150 offset:18432
    v_mfma_f32_16x16x32_bf16 v[100:103], v[40:43], v[172:175], v[100:103]
    buffer_load_dwordx4 v[220:223], v159, s[8:11], s62 offen offset:3072 sc1
    s_add_u32 s62, s62, 4096
    s_cmp_eq_u32 s62, s24
    s_cselect_b32 s62, s21, s62
    v_mfma_f32_16x16x32_bf16 v[84:87], v[44:47], v[168:171], v[84:87]
    ds_read_b128 v[24:27], v150 offset:19456
    v_mfma_f32_16x16x32_bf16 v[104:107], v[44:47], v[172:175], v[104:107]
    s_waitcnt vmcnt(10) lgkmcnt(5)
    v_mfma_f32_16x16x32_bf16 v[68:71], v[48:51], v[176:179], v[68:71]
    ds_read_b128 v[28:31], v151 offset:0
    v_mfma_f32_16x16x32_bf16 v[88:91], v[48:51], v[180:183], v[88:91]
    v_mfma_f32_16x16x32_bf16 v[72:75], v[52:55], v[176:179], v[72:75]
    ds_read_b128 v[32:35], v151 offset:1024
    v_mfma_f32_16x16x32_bf16 v[92:95], v[52:55], v[180:183], v[92:95]
    buffer_load_dwordx4 v[160:163], v158, s[8:11], s62 offen offset:0 sc1
    v_mfma_f32_16x16x32_bf16 v[76:79], v[56:59], v[176:179], v[76:79]
    ds_read_b128 v[36:39], v151 offset:2048
    v_mfma_f32_16x16x32_bf16 v[96:99], v[56:59], v[180:183], v[96:99]
    v_mfma_f32_16x16x32_bf16 v[80:83], v[60:63], v[176:179], v[80:83]
    ds_read_b128 v[40:43], v151 offset:3072
    v_mfma_f32_16x16x32_bf16 v[100:103], v[60:63], v[180:183], v[100:103]
    buffer_load_dwordx4 v[164:167], v159, s[8:11], s62 offen offset:0 sc1
    v_mfma_f32_16x16x32_bf16 v[84:87], v[64:67], v[176:179], v[84:87]
    ds_read_b128 v[44:47], v151 offset:4096
    v_mfma_f32_16x16x32_bf16 v[104:107], v[64:67], v[180:183], v[104:107]
    s_waitcnt vmcnt(10) lgkmcnt(5)
    v_mfma_f32_16x16x32_bf16 v[68:71], v[8:11], v[184:187], v[68:71]
    ds_read_b128 v[48:51], v151 offset:5120
    v_mfma_f32_16x16x32_bf16 v[88:91], v[8:11], v[188:191], v[88:91]
    v_mfma_f32_16x16x32_bf16 v[72:75], v[12:15], v[184:187], v[72:75]
    ds_read_b128 v[52:55], v151 offset:6144
    v_mfma_f32_16x16x32_bf16 v[92:95], v[12:15], v[188:191], v[92:95]
    buffer_load_dwordx4 v[168:171], v158, s[8:11], s62 offen offset:1024 sc1
    v_mfma_f32_16x16x32_bf16 v[76:79], v[16:19], v[184:187], v[76:79]
    ds_read_b128 v[56:59], v151 offset:7168
    v_mfma_f32_16x16x32_bf16 v[96:99], v[16:19], v[188:191], v[96:99]
    v_mfma_f32_16x16x32_bf16 v[80:83], v[20:23], v[184:187], v[80:83]
    ds_read_b128 v[60:63], v151 offset:8192
    v_mfma_f32_16x16x32_bf16 v[100:103], v[20:23], v[188:191], v[100:103]
    buffer_load_dwordx4 v[172:175], v159, s[8:11], s62 offen offset:1024 sc1
    v_mfma_f32_16x16x32_bf16 v[84:87], v[24:27], v[184:187], v[84:87]
    ds_read_b128 v[64:67], v151 offset:9216
    v_mfma_f32_16x16x32_bf16 v[104:107], v[24:27], v[188:191], v[104:107]
    s_barrier
    s_waitcnt vmcnt(10) lgkmcnt(5)
    v_mfma_f32_16x16x32_bf16 v[68:71], v[28:31], v[192:195], v[68:71]
    ds_read_b128 v[8:11], v151 offset:10240
    v_mfma_f32_16x16x32_bf16 v[88:91], v[28:31], v[196:199], v[88:91]
    v_mfma_f32_16x16x32_bf16 v[72:75], v[32:35], v[192:195], v[72:75]
    ds_read_b128 v[12:15], v151 offset:11264
    v_mfma_f32_16x16x32_bf16 v[92:95], v[32:35], v[196:199], v[92:95]
    buffer_load_dwordx4 v[176:179], v158, s[8:11], s62 offen offset:2048 sc1
    v_mfma_f32_16x16x32_bf16 v[76:79], v[36:39], v[192:195], v[76:79]
    ds_read_b128 v[16:19], v151 offset:12288
    v_mfma_f32_16x16x32_bf16 v[96:99], v[36:39], v[196:199], v[96:99]
    v_mfma_f32_16x16x32_bf16 v[80:83], v[40:43], v[192:195], v[80:83]
    ds_read_b128 v[20:23], v151 offset:13312
    v_mfma_f32_16x16x32_bf16 v[100:103], v[40:43], v[196:199], v[100:103]
    buffer_load_dwordx4 v[180:183], v159, s[8:11], s62 offen offset:2048 sc1
    v_mfma_f32_16x16x32_bf16 v[84:87], v[44:47], v[192:195], v[84:87]
    ds_read_b128 v[24:27], v151 offset:14336
    v_mfma_f32_16x16x32_bf16 v[104:107], v[44:47], v[196:199], v[104:107]
    s_waitcnt vmcnt(10) lgkmcnt(5)
    v_mfma_f32_16x16x32_bf16 v[68:71], v[48:51], v[200:203], v[68:71]
    ds_read_b128 v[28:31], v151 offset:15360
    v_mfma_f32_16x16x32_bf16 v[88:91], v[48:51], v[204:207], v[88:91]
    v_mfma_f32_16x16x32_bf16 v[72:75], v[52:55], v[200:203], v[72:75]
    ds_read_b128 v[32:35], v151 offset:16384
    v_mfma_f32_16x16x32_bf16 v[92:95], v[52:55], v[204:207], v[92:95]
    buffer_load_dwordx4 v[184:187], v158, s[8:11], s62 offen offset:3072 sc1
    v_mfma_f32_16x16x32_bf16 v[76:79], v[56:59], v[200:203], v[76:79]
    ds_read_b128 v[36:39], v151 offset:17408
    v_mfma_f32_16x16x32_bf16 v[96:99], v[56:59], v[204:207], v[96:99]
    v_mfma_f32_16x16x32_bf16 v[80:83], v[60:63], v[200:203], v[80:83]
    ds_read_b128 v[40:43], v151 offset:18432
    v_mfma_f32_16x16x32_bf16 v[100:103], v[60:63], v[204:207], v[100:103]
    buffer_load_dwordx4 v[188:191], v159, s[8:11], s62 offen offset:3072 sc1
    s_add_u32 s62, s62, 4096
    s_cmp_eq_u32 s62, s24
    s_cselect_b32 s62, s21, s62
    v_mfma_f32_16x16x32_bf16 v[84:87], v[64:67], v[200:203], v[84:87]
    ds_read_b128 v[44:47], v151 offset:19456
    v_mfma_f32_16x16x32_bf16 v[104:107], v[64:67], v[204:207], v[104:107]
    s_waitcnt vmcnt(10) lgkmcnt(5)
    v_mfma_f32_16x16x32_bf16 v[68:71], v[8:11], v[208:211], v[68:71]
    ds_read_b128 v[48:51], v151 offset:20480
    v_mfma_f32_16x16x32_bf16 v[88:91], v[8:11], v[212:215], v[88:91]
    v_mfma_f32_16x16x32_bf16 v[72:75], v[12:15], v[208:211], v[72:75]
    ds_read_b128 v[52:55], v151 offset:21504
    v_mfma_f32_16x16x32_bf16 v[92:95], v[12:15], v[212:215], v[92:95]
    buffer_load_dwordx4 v[192:195], v158, s[8:11], s62 offen offset:0 sc1
    v_mfma_f32_16x16x32_bf16 v[76:79], v[16:19], v[208:211], v[76:79]
    ds_read_b128 v[56:59], v151 offset:22528
    v_mfma_f32_16x16x32_bf16 v[96:99], v[16:19], v[212:215], v[96:99]
    v_mfma_f32_16x16x32_bf16 v[80:83], v[20:23], v[208:211], v[80:83]
    ds_read_b128 v[60:63], v151 offset:23552
    v_mfma_f32_16x16x32_bf16 v[100:103], v[20:23], v[212:215], v[100:103]
    buffer_load_dwordx4 v[196:199], v159, s[8:11], s62 offen offset:0 sc1
    v_mfma_f32_16x16x32_bf16 v[84:87], v[24:27], v[208:211], v[84:87]
    ds_read_b128 v[64:67], v151 offset:24576
    v_mfma_f32_16x16x32_bf16 v[104:107], v[24:27], v[212:215], v[104:107]
    s_waitcnt vmcnt(10) lgkmcnt(5)
    v_mfma_f32_16x16x32_bf16 v[68:71], v[28:31], v[216:219], v[68:71]
    ds_read_b128 v[8:11], v151 offset:25600
    v_mfma_f32_16x16x32_bf16 v[88:91], v[28:31], v[220:223], v[88:91]
    v_mfma_f32_16x16x32_bf16 v[72:75], v[32:35], v[216:219], v[72:75]
    ds_read_b128 v[12:15], v151 offset:26624
    v_mfma_f32_16x16x32_bf16 v[92:95], v[32:35], v[220:223], v[92:95]
    buffer_load_dwordx4 v[200:203], v158, s[8:11], s62 offen offset:1024 sc1
    v_mfma_f32_16x16x32_bf16 v[76:79], v[36:39], v[216:219], v[76:79]
    ds_read_b128 v[16:19], v151 offset:27648
    v_mfma_f32_16x16x32_bf16 v[96:99], v[36:39], v[220:223], v[96:99]
    v_mfma_f32_16x16x32_bf16 v[80:83], v[40:43], v[216:219], v[80:83]
    ds_read_b128 v[20:23], v151 offset:28672
    v_mfma_f32_16x16x32_bf16 v[100:103], v[40:43], v[220:223], v[100:103]
    buffer_load_dwordx4 v[204:207], v159, s[8:11], s62 offen offset:1024 sc1
    v_mfma_f32_16x16x32_bf16 v[84:87], v[44:47], v[216:219], v[84:87]
    ds_read_b128 v[24:27], v151 offset:29696
    v_mfma_f32_16x16x32_bf16 v[104:107], v[44:47], v[220:223], v[104:107]
    s_barrier
    s_waitcnt vmcnt(10) lgkmcnt(5)
    v_mfma_f32_16x16x32_bf16 v[68:71], v[48:51], v[160:163], v[68:71]
    ds_read_b128 v[28:31], v151 offset:30720
    v_mfma_f32_16x16x32_bf16 v[88:91], v[48:51], v[164:167], v[88:91]
    v_mfma_f32_16x16x32_bf16 v[72:75], v[52:55], v[160:163], v[72:75]
    ds_read_b128 v[32:35], v151 offset:31744
    v_mfma_f32_16x16x32_bf16 v[92:95], v[52:55], v[164:167], v[92:95]
    buffer_load_dwordx4 v[208:211], v158, s[8:11], s62 offen offset:2048 sc1
    v_mfma_f32_16x16x32_bf16 v[76:79], v[56:59], v[160:163], v[76:79]
    ds_read_b128 v[36:39], v151 offset:32768
    v_mfma_f32_16x16x32_bf16 v[96:99], v[56:59], v[164:167], v[96:99]
    v_mfma_f32_16x16x32_bf16 v[80:83], v[60:63], v[160:163], v[80:83]
    ds_read_b128 v[40:43], v151 offset:33792
    v_mfma_f32_16x16x32_bf16 v[100:103], v[60:63], v[164:167], v[100:103]
    buffer_load_dwordx4 v[212:215], v159, s[8:11], s62 offen offset:2048 sc1
    v_mfma_f32_16x16x32_bf16 v[84:87], v[64:67], v[160:163], v[84:87]
    ds_read_b128 v[44:47], v151 offset:34816
    v_mfma_f32_16x16x32_bf16 v[104:107], v[64:67], v[164:167], v[104:107]
    s_waitcnt vmcnt(10) lgkmcnt(5)
    v_mfma_f32_16x16x32_bf16 v[68:71], v[8:11], v[168:171], v[68:71]
    ds_read_b128 v[48:51], v151 offset:35840
    v_mfma_f32_16x16x32_bf16 v[88:91], v[8:11], v[172:175], v[88:91]
    v_mfma_f32_16x16x32_bf16 v[72:75], v[12:15], v[168:171], v[72:75]
    ds_read_b128 v[52:55], v151 offset:36864
    v_mfma_f32_16x16x32_bf16 v[92:95], v[12:15], v[172:175], v[92:95]
    buffer_load_dwordx4 v[216:219], v158, s[8:11], s62 offen offset:3072 sc1
    v_mfma_f32_16x16x32_bf16 v[76:79], v[16:19], v[168:171], v[76:79]
    ds_read_b128 v[56:59], v151 offset:37888
    v_mfma_f32_16x16x32_bf16 v[96:99], v[16:19], v[172:175], v[96:99]
    v_mfma_f32_16x16x32_bf16 v[80:83], v[20:23], v[168:171], v[80:83]
    ds_read_b128 v[60:63], v151 offset:38912
    v_mfma_f32_16x16x32_bf16 v[100:103], v[20:23], v[172:175], v[100:103]
    buffer_load_dwordx4 v[220:223], v159, s[8:11], s62 offen offset:3072 sc1
    s_add_u32 s62, s62, 4096
    s_cmp_eq_u32 s62, s24
    s_cselect_b32 s62, s21, s62
    v_mfma_f32_16x16x32_bf16 v[84:87], v[24:27], v[168:171], v[84:87]
    ds_read_b128 v[64:67], v151 offset:39936
    v_mfma_f32_16x16x32_bf16 v[104:107], v[24:27], v[172:175], v[104:107]
    s_waitcnt vmcnt(10) lgkmcnt(5)
    v_mfma_f32_16x16x32_bf16 v[68:71], v[28:31], v[176:179], v[68:71]
    ds_read_b128 v[8:11], v151 offset:40960
    v_mfma_f32_16x16x32_bf16 v[88:91], v[28:31], v[180:183], v[88:91]
    v_mfma_f32_16x16x32_bf16 v[72:75], v[32:35], v[176:179], v[72:75]
    ds_read_b128 v[12:15], v151 offset:41984
    v_mfma_f32_16x16x32_bf16 v[92:95], v[32:35], v[180:183], v[92:95]
    buffer_load_dwordx4 v[160:163], v158, s[8:11], s62 offen offset:0 sc1
    v_mfma_f32_16x16x32_bf16 v[76:79], v[36:39], v[176:179], v[76:79]
    ds_read_b128 v[16:19], v151 offset:43008
    v_mfma_f32_16x16x32_bf16 v[96:99], v[36:39], v[180:183], v[96:99]
    v_mfma_f32_16x16x32_bf16 v[80:83], v[40:43], v[176:179], v[80:83]
    ds_read_b128 v[20:23], v151 offset:44032
    v_mfma_f32_16x16x32_bf16 v[100:103], v[40:43], v[180:183], v[100:103]
    buffer_load_dwordx4 v[164:167], v159, s[8:11], s62 offen offset:0 sc1
    v_mfma_f32_16x16x32_bf16 v[84:87], v[44:47], v[176:179], v[84:87]
    ds_read_b128 v[24:27], v151 offset:45056
    v_mfma_f32_16x16x32_bf16 v[104:107], v[44:47], v[180:183], v[104:107]
    s_waitcnt vmcnt(10) lgkmcnt(5)
    v_mfma_f32_16x16x32_bf16 v[68:71], v[48:51], v[184:187], v[68:71]
    ds_read_b128 v[28:31], v151 offset:46080
    v_mfma_f32_16x16x32_bf16 v[88:91], v[48:51], v[188:191], v[88:91]
    v_mfma_f32_16x16x32_bf16 v[72:75], v[52:55], v[184:187], v[72:75]
    ds_read_b128 v[32:35], v151 offset:47104
    v_mfma_f32_16x16x32_bf16 v[92:95], v[52:55], v[188:191], v[92:95]
    buffer_load_dwordx4 v[168:171], v158, s[8:11], s62 offen offset:1024 sc1
    v_mfma_f32_16x16x32_bf16 v[76:79], v[56:59], v[184:187], v[76:79]
    ds_read_b128 v[36:39], v151 offset:48128
    v_mfma_f32_16x16x32_bf16 v[96:99], v[56:59], v[188:191], v[96:99]
    v_mfma_f32_16x16x32_bf16 v[80:83], v[60:63], v[184:187], v[80:83]
    ds_read_b128 v[40:43], v151 offset:49152
    v_mfma_f32_16x16x32_bf16 v[100:103], v[60:63], v[188:191], v[100:103]
    buffer_load_dwordx4 v[172:175], v159, s[8:11], s62 offen offset:1024 sc1
    v_mfma_f32_16x16x32_bf16 v[84:87], v[64:67], v[184:187], v[84:87]
    ds_read_b128 v[44:47], v151 offset:50176
    v_mfma_f32_16x16x32_bf16 v[104:107], v[64:67], v[188:191], v[104:107]
    s_waitcnt vmcnt(10) lgkmcnt(5)
    v_mfma_f32_16x16x32_bf16 v[68:71], v[8:11], v[192:195], v[68:71]
    ds_read_b128 v[48:51], v151 offset:51200
    v_mfma_f32_16x16x32_bf16 v[88:91], v[8:11], v[196:199], v[88:91]
    v_mfma_f32_16x16x32_bf16 v[72:75], v[12:15], v[192:195], v[72:75]
    ds_read_b128 v[52:55], v151 offset:52224
    v_mfma_f32_16x16x32_bf16 v[92:95], v[12:15], v[196:199], v[92:95]
    buffer_load_dwordx4 v[176:179], v158, s[8:11], s62 offen offset:2048 sc1
    v_mfma_f32_16x16x32_bf16 v[76:79], v[16:19], v[192:195], v[76:79]
    ds_read_b128 v[56:59], v151 offset:53248
    v_mfma_f32_16x16x32_bf16 v[96:99], v[16:19], v[196:199], v[96:99]
    v_mfma_f32_16x16x32_bf16 v[80:83], v[20:23], v[192:195], v[80:83]
    ds_read_b128 v[60:63], v151 offset:54272
    v_mfma_f32_16x16x32_bf16 v[100:103], v[20:23], v[196:199], v[100:103]
    buffer_load_dwordx4 v[180:183], v159, s[8:11], s62 offen offset:2048 sc1
    v_mfma_f32_16x16x32_bf16 v[84:87], v[24:27], v[192:195], v[84:87]
    ds_read_b128 v[64:67], v151 offset:55296
    v_mfma_f32_16x16x32_bf16 v[104:107], v[24:27], v[196:199], v[104:107]
    s_waitcnt vmcnt(10) lgkmcnt(5)
    v_mfma_f32_16x16x32_bf16 v[68:71], v[28:31], v[200:203], v[68:71]
    ds_read_b128 v[8:11], v151 offset:56320
    v_mfma_f32_16x16x32_bf16 v[88:91], v[28:31], v[204:207], v[88:91]
    v_mfma_f32_16x16x32_bf16 v[72:75], v[32:35], v[200:203], v[72:75]
    ds_read_b128 v[12:15], v151 offset:57344
    v_mfma_f32_16x16x32_bf16 v[92:95], v[32:35], v[204:207], v[92:95]
    buffer_load_dwordx4 v[184:187], v158, s[8:11], s62 offen offset:3072 sc1
    v_mfma_f32_16x16x32_bf16 v[76:79], v[36:39], v[200:203], v[76:79]
    ds_read_b128 v[16:19], v151 offset:58368
    v_mfma_f32_16x16x32_bf16 v[96:99], v[36:39], v[204:207], v[96:99]
    v_mfma_f32_16x16x32_bf16 v[80:83], v[40:43], v[200:203], v[80:83]
    ds_read_b128 v[20:23], v151 offset:59392
    v_mfma_f32_16x16x32_bf16 v[100:103], v[40:43], v[204:207], v[100:103]
    buffer_load_dwordx4 v[188:191], v159, s[8:11], s62 offen offset:3072 sc1
    s_add_u32 s62, s62, 4096
    s_cmp_eq_u32 s62, s24
    s_cselect_b32 s62, s21, s62
    v_mfma_f32_16x16x32_bf16 v[84:87], v[44:47], v[200:203], v[84:87]
    ds_read_b128 v[24:27], v151 offset:60416
    v_mfma_f32_16x16x32_bf16 v[104:107], v[44:47], v[204:207], v[104:107]
    s_barrier
    s_waitcnt vmcnt(10) lgkmcnt(5)
    v_mfma_f32_16x16x32_bf16 v[68:71], v[48:51], v[208:211], v[68:71]
    ds_read_b128 v[28:31], v150 offset:0
    v_mfma_f32_16x16x32_bf16 v[88:91], v[48:51], v[212:215], v[88:91]
    v_mfma_f32_16x16x32_bf16 v[72:75], v[52:55], v[208:211], v[72:75]
    ds_read_b128 v[32:35], v150 offset:1024
    v_mfma_f32_16x16x32_bf16 v[92:95], v[52:55], v[212:215], v[92:95]
    buffer_load_dwordx4 v[192:195], v158, s[8:11], s62 offen offset:0 sc1
    v_mfma_f32_16x16x32_bf16 v[76:79], v[56:59], v[208:211], v[76:79]
    ds_read_b128 v[36:39], v150 offset:2048
    v_mfma_f32_16x16x32_bf16 v[96:99], v[56:59], v[212:215], v[96:99]
    v_mfma_f32_16x16x32_bf16 v[80:83], v[60:63], v[208:211], v[80:83]
    ds_read_b128 v[40:43], v150 offset:3072
    v_mfma_f32_16x16x32_bf16 v[100:103], v[60:63], v[212:215], v[100:103]
    buffer_load_dwordx4 v[196:199], v159, s[8:11], s62 offen offset:0 sc1
    v_mfma_f32_16x16x32_bf16 v[84:87], v[64:67], v[208:211], v[84:87]
    ds_read_b128 v[44:47], v150 offset:4096
    v_mfma_f32_16x16x32_bf16 v[104:107], v[64:67], v[212:215], v[104:107]
    s_waitcnt vmcnt(10) lgkmcnt(5)
    v_mfma_f32_16x16x32_bf16 v[68:71], v[8:11], v[216:219], v[68:71]
    ds_read_b128 v[48:51], v150 offset:5120
    v_mfma_f32_16x16x32_bf16 v[88:91], v[8:11], v[220:223], v[88:91]
    v_mfma_f32_16x16x32_bf16 v[72:75], v[12:15], v[216:219], v[72:75]
    ds_read_b128 v[52:55], v150 offset:6144
    v_mfma_f32_16x16x32_bf16 v[92:95], v[12:15], v[220:223], v[92:95]
    buffer_load_dwordx4 v[200:203], v158, s[8:11], s62 offen offset:1024 sc1
    v_mfma_f32_16x16x32_bf16 v[76:79], v[16:19], v[216:219], v[76:79]
    ds_read_b128 v[56:59], v150 offset:7168
    v_mfma_f32_16x16x32_bf16 v[96:99], v[16:19], v[220:223], v[96:99]
    v_mfma_f32_16x16x32_bf16 v[80:83], v[20:23], v[216:219], v[80:83]
    ds_read_b128 v[60:63], v150 offset:8192
    v_mfma_f32_16x16x32_bf16 v[100:103], v[20:23], v[220:223], v[100:103]
    buffer_load_dwordx4 v[204:207], v159, s[8:11], s62 offen offset:1024 sc1
    v_mfma_f32_16x16x32_bf16 v[84:87], v[24:27], v[216:219], v[84:87]
    ds_read_b128 v[64:67], v150 offset:9216
    v_mfma_f32_16x16x32_bf16 v[104:107], v[24:27], v[220:223], v[104:107]
    s_waitcnt vmcnt(10) lgkmcnt(5)
    v_mfma_f32_16x16x32_bf16 v[68:71], v[28:31], v[160:163], v[68:71]
    ds_read_b128 v[8:11], v150 offset:10240
    v_mfma_f32_16x16x32_bf16 v[88:91], v[28:31], v[164:167], v[88:91]
    v_mfma_f32_16x16x32_bf16 v[72:75], v[32:35], v[160:163], v[72:75]
    ds_read_b128 v[12:15], v150 offset:11264
    v_mfma_f32_16x16x32_bf16 v[92:95], v[32:35], v[164:167], v[92:95]
    buffer_load_dwordx4 v[208:211], v158, s[8:11], s62 offen offset:2048 sc1
    v_mfma_f32_16x16x32_bf16 v[76:79], v[36:39], v[160:163], v[76:79]
    ds_read_b128 v[16:19], v150 offset:12288
    v_mfma_f32_16x16x32_bf16 v[96:99], v[36:39], v[164:167], v[96:99]
    v_mfma_f32_16x16x32_bf16 v[80:83], v[40:43], v[160:163], v[80:83]
    ds_read_b128 v[20:23], v150 offset:13312
    v_mfma_f32_16x16x32_bf16 v[100:103], v[40:43], v[164:167], v[100:103]
    buffer_load_dwordx4 v[212:215], v159, s[8:11], s62 offen offset:2048 sc1
    v_mfma_f32_16x16x32_bf16 v[84:87], v[44:47], v[160:163], v[84:87]
    ds_read_b128 v[24:27], v150 offset:14336
    v_mfma_f32_16x16x32_bf16 v[104:107], v[44:47], v[164:167], v[104:107]
    s_lshl_b32 s17, s27, 6
    s_add_u32 s17, s17, s29
    s_lshl1_add_u32 s17, s17, s27
    s_lshl_b32 s17, s17, 6
    s_add_u32 s17, s17, 19857408
    v_and_b32 v4, 15, v1
    v_lshlrev_b32 v4, 2, v4
    buffer_load_dword v140, v4, s[8:11], s17 offen sc1
    s_waitcnt vmcnt(11) lgkmcnt(5)
    v_mfma_f32_16x16x32_bf16 v[68:71], v[48:51], v[168:171], v[68:71]
    ds_read_b128 v[28:31], v150 offset:15360
    v_mfma_f32_16x16x32_bf16 v[88:91], v[48:51], v[172:175], v[88:91]
    v_mfma_f32_16x16x32_bf16 v[72:75], v[52:55], v[168:171], v[72:75]
    ds_read_b128 v[32:35], v150 offset:16384
    v_mfma_f32_16x16x32_bf16 v[92:95], v[52:55], v[172:175], v[92:95]
    buffer_load_dwordx4 v[216:219], v158, s[8:11], s62 offen offset:3072 sc1
    v_mfma_f32_16x16x32_bf16 v[76:79], v[56:59], v[168:171], v[76:79]
    ds_read_b128 v[36:39], v150 offset:17408
    v_mfma_f32_16x16x32_bf16 v[96:99], v[56:59], v[172:175], v[96:99]
    v_mfma_f32_16x16x32_bf16 v[80:83], v[60:63], v[168:171], v[80:83]
    ds_read_b128 v[40:43], v150 offset:18432
    v_mfma_f32_16x16x32_bf16 v[100:103], v[60:63], v[172:175], v[100:103]
    buffer_load_dwordx4 v[220:223], v159, s[8:11], s62 offen offset:3072 sc1
    v_mfma_f32_16x16x32_bf16 v[84:87], v[64:67], v[168:171], v[84:87]
    ds_read_b128 v[44:47], v150 offset:19456
    v_mfma_f32_16x16x32_bf16 v[104:107], v[64:67], v[172:175], v[104:107]
    s_barrier
    s_waitcnt vmcnt(11) lgkmcnt(5)
    v_mfma_f32_16x16x32_bf16 v[68:71], v[8:11], v[176:179], v[68:71]
    ds_read_b128 v[48:51], v151 offset:0
    v_mfma_f32_16x16x32_bf16 v[88:91], v[8:11], v[180:183], v[88:91]
    v_mfma_f32_16x16x32_bf16 v[72:75], v[12:15], v[176:179], v[72:75]
    ds_read_b128 v[52:55], v151 offset:1024
    v_mfma_f32_16x16x32_bf16 v[92:95], v[12:15], v[180:183], v[92:95]
    v_mfma_f32_16x16x32_bf16 v[76:79], v[16:19], v[176:179], v[76:79]
    ds_read_b128 v[56:59], v151 offset:2048
    v_mfma_f32_16x16x32_bf16 v[96:99], v[16:19], v[180:183], v[96:99]
    v_mfma_f32_16x16x32_bf16 v[80:83], v[20:23], v[176:179], v[80:83]
    ds_read_b128 v[60:63], v151 offset:3072
    v_mfma_f32_16x16x32_bf16 v[100:103], v[20:23], v[180:183], v[100:103]
    v_mfma_f32_16x16x32_bf16 v[84:87], v[24:27], v[176:179], v[84:87]
    ds_read_b128 v[64:67], v151 offset:4096
    v_mfma_f32_16x16x32_bf16 v[104:107], v[24:27], v[180:183], v[104:107]
    s_waitcnt vmcnt(9) lgkmcnt(5)
    v_mfma_f32_16x16x32_bf16 v[68:71], v[28:31], v[184:187], v[68:71]
    ds_read_b128 v[8:11], v151 offset:5120
    v_mfma_f32_16x16x32_bf16 v[88:91], v[28:31], v[188:191], v[88:91]
    v_mfma_f32_16x16x32_bf16 v[72:75], v[32:35], v[184:187], v[72:75]
    ds_read_b128 v[12:15], v151 offset:6144
    v_mfma_f32_16x16x32_bf16 v[92:95], v[32:35], v[188:191], v[92:95]
    v_mfma_f32_16x16x32_bf16 v[76:79], v[36:39], v[184:187], v[76:79]
    ds_read_b128 v[16:19], v151 offset:7168
    v_mfma_f32_16x16x32_bf16 v[96:99], v[36:39], v[188:191], v[96:99]
    v_mfma_f32_16x16x32_bf16 v[80:83], v[40:43], v[184:187], v[80:83]
    ds_read_b128 v[20:23], v151 offset:8192
    v_mfma_f32_16x16x32_bf16 v[100:103], v[40:43], v[188:191], v[100:103]
    v_mfma_f32_16x16x32_bf16 v[84:87], v[44:47], v[184:187], v[84:87]
    ds_read_b128 v[24:27], v151 offset:9216
    v_mfma_f32_16x16x32_bf16 v[104:107], v[44:47], v[188:191], v[104:107]
    s_waitcnt vmcnt(7) lgkmcnt(5)
    v_mfma_f32_16x16x32_bf16 v[68:71], v[48:51], v[192:195], v[68:71]
    ds_read_b128 v[28:31], v151 offset:10240
    v_mfma_f32_16x16x32_bf16 v[88:91], v[48:51], v[196:199], v[88:91]
    v_mfma_f32_16x16x32_bf16 v[72:75], v[52:55], v[192:195], v[72:75]
    ds_read_b128 v[32:35], v151 offset:11264
    v_mfma_f32_16x16x32_bf16 v[92:95], v[52:55], v[196:199], v[92:95]
    v_mfma_f32_16x16x32_bf16 v[76:79], v[56:59], v[192:195], v[76:79]
    ds_read_b128 v[36:39], v151 offset:12288
    v_mfma_f32_16x16x32_bf16 v[96:99], v[56:59], v[196:199], v[96:99]
    v_mfma_f32_16x16x32_bf16 v[80:83], v[60:63], v[192:195], v[80:83]
    ds_read_b128 v[40:43], v151 offset:13312
    v_mfma_f32_16x16x32_bf16 v[100:103], v[60:63], v[196:199], v[100:103]
    v_mfma_f32_16x16x32_bf16 v[84:87], v[64:67], v[192:195], v[84:87]
    ds_read_b128 v[44:47], v151 offset:14336
    v_mfma_f32_16x16x32_bf16 v[104:107], v[64:67], v[196:199], v[104:107]
    s_waitcnt vmcnt(5) lgkmcnt(5)
    v_mfma_f32_16x16x32_bf16 v[68:71], v[8:11], v[200:203], v[68:71]
    ds_read_b128 v[48:51], v151 offset:15360
    v_mfma_f32_16x16x32_bf16 v[88:91], v[8:11], v[204:207], v[88:91]
    v_mfma_f32_16x16x32_bf16 v[72:75], v[12:15], v[200:203], v[72:75]
    ds_read_b128 v[52:55], v151 offset:16384
    v_mfma_f32_16x16x32_bf16 v[92:95], v[12:15], v[204:207], v[92:95]
    v_mfma_f32_16x16x32_bf16 v[76:79], v[16:19], v[200:203], v[76:79]
    ds_read_b128 v[56:59], v151 offset:17408
    v_mfma_f32_16x16x32_bf16 v[96:99], v[16:19], v[204:207], v[96:99]
    v_mfma_f32_16x16x32_bf16 v[80:83], v[20:23], v[200:203], v[80:83]
    ds_read_b128 v[60:63], v151 offset:18432
    v_mfma_f32_16x16x32_bf16 v[100:103], v[20:23], v[204:207], v[100:103]
    v_mfma_f32_16x16x32_bf16 v[84:87], v[24:27], v[200:203], v[84:87]
    ds_read_b128 v[64:67], v151 offset:19456
    v_mfma_f32_16x16x32_bf16 v[104:107], v[24:27], v[204:207], v[104:107]
    s_waitcnt vmcnt(0) lgkmcnt(0)
    v_mfma_f32_16x16x32_bf16 v[88:91], v[28:31], v[212:215], v[88:91]
    v_mfma_f32_16x16x32_bf16 v[88:91], v[48:51], v[220:223], v[88:91]
    v_mfma_f32_16x16x32_bf16 v[92:95], v[32:35], v[212:215], v[92:95]
    v_mfma_f32_16x16x32_bf16 v[92:95], v[52:55], v[220:223], v[92:95]
    v_mfma_f32_16x16x32_bf16 v[96:99], v[36:39], v[212:215], v[96:99]
    v_mfma_f32_16x16x32_bf16 v[96:99], v[56:59], v[220:223], v[96:99]
    v_mfma_f32_16x16x32_bf16 v[100:103], v[40:43], v[212:215], v[100:103]
    v_mfma_f32_16x16x32_bf16 v[100:103], v[60:63], v[220:223], v[100:103]
    v_mfma_f32_16x16x32_bf16 v[104:107], v[44:47], v[212:215], v[104:107]
    v_mfma_f32_16x16x32_bf16 v[104:107], v[64:67], v[220:223], v[104:107]
    v_mfma_f32_16x16x32_bf16 v[68:71], v[28:31], v[208:211], v[68:71]
    v_mfma_f32_16x16x32_bf16 v[68:71], v[48:51], v[216:219], v[68:71]
    ds_write_b128 v2, v[88:91] offset:0
    v_mfma_f32_16x16x32_bf16 v[72:75], v[32:35], v[208:211], v[72:75]
    v_mfma_f32_16x16x32_bf16 v[72:75], v[52:55], v[216:219], v[72:75]
    ds_write_b128 v2, v[92:95] offset:1024
    v_mfma_f32_16x16x32_bf16 v[76:79], v[36:39], v[208:211], v[76:79]
    v_mfma_f32_16x16x32_bf16 v[76:79], v[56:59], v[216:219], v[76:79]
    ds_write_b128 v2, v[96:99] offset:2048
    v_mfma_f32_16x16x32_bf16 v[80:83], v[40:43], v[208:211], v[80:83]
    v_mfma_f32_16x16x32_bf16 v[80:83], v[60:63], v[216:219], v[80:83]
    ds_write_b128 v2, v[100:103] offset:3072
    v_mfma_f32_16x16x32_bf16 v[84:87], v[44:47], v[208:211], v[84:87]
    v_mfma_f32_16x16x32_bf16 v[84:87], v[64:67], v[216:219], v[84:87]
    ds_write_b128 v2, v[104:107] offset:4096
    s_waitcnt vmcnt(0)
    v_pk_fma_f32 v[68:69], v[68:69], v[140:141], v[232:233] op_sel_hi:[1,0,1]
    v_pk_fma_f32 v[70:71], v[70:71], v[140:141], v[234:235] op_sel_hi:[1,0,1]
    v_pk_fma_f32 v[72:73], v[72:73], v[140:141], v[236:237] op_sel_hi:[1,0,1]
    v_pk_fma_f32 v[74:75], v[74:75], v[140:141], v[238:239] op_sel_hi:[1,0,1]
    v_pk_fma_f32 v[76:77], v[76:77], v[140:141], v[240:241] op_sel_hi:[1,0,1]
    v_pk_fma_f32 v[78:79], v[78:79], v[140:141], v[242:243] op_sel_hi:[1,0,1]
    v_pk_fma_f32 v[80:81], v[80:81], v[140:141], v[244:245] op_sel_hi:[1,0,1]
    v_pk_fma_f32 v[82:83], v[82:83], v[140:141], v[246:247] op_sel_hi:[1,0,1]
    v_pk_fma_f32 v[84:85], v[84:85], v[140:141], v[248:249] op_sel_hi:[1,0,1]
    v_pk_fma_f32 v[86:87], v[86:87], v[140:141], v[250:251] op_sel_hi:[1,0,1]
    v_add_u32 v4, 40960, v155
    s_mul_i32 s18, s13, 2560
    s_add_u32 s18, s18, 40960
    v_add_u32 v5, s18, v7
    s_waitcnt lgkmcnt(0)
    s_barrier
    ds_read_b128 v[48:51], v3 offset:0
    ds_read_b128 v[52:55], v3 offset:1024
    ds_read_b128 v[56:59], v3 offset:2048
    ds_read_b128 v[60:63], v3 offset:3072
    ds_read_b128 v[64:67], v3 offset:4096
    s_waitcnt lgkmcnt(4)
    v_pk_fma_f32 v[68:69], v[48:49], v[140:141], v[68:69] op_sel_hi:[1,0,1]
    v_pk_fma_f32 v[70:71], v[50:51], v[140:141], v[70:71] op_sel_hi:[1,0,1]
    v_cvt_pk_bf16_f32 v108, v68, v69
    v_cvt_pk_bf16_f32 v109, v70, v71
    ds_write_b64 v4, v[108:109] offset:0
    s_waitcnt lgkmcnt(4)
    v_pk_fma_f32 v[72:73], v[52:53], v[140:141], v[72:73] op_sel_hi:[1,0,1]
    v_pk_fma_f32 v[74:75], v[54:55], v[140:141], v[74:75] op_sel_hi:[1,0,1]
    v_cvt_pk_bf16_f32 v110, v72, v73
    v_cvt_pk_bf16_f32 v111, v74, v75
    ds_write_b64 v4, v[110:111] offset:32
    s_waitcnt lgkmcnt(4)
    v_pk_fma_f32 v[76:77], v[56:57], v[140:141], v[76:77] op_sel_hi:[1,0,1]
    v_pk_fma_f32 v[78:79], v[58:59], v[140:141], v[78:79] op_sel_hi:[1,0,1]
    v_cvt_pk_bf16_f32 v112, v76, v77
    v_cvt_pk_bf16_f32 v113, v78, v79
    ds_write_b64 v4, v[112:113] offset:64
    s_waitcnt lgkmcnt(4)
    v_pk_fma_f32 v[80:81], v[60:61], v[140:141], v[80:81] op_sel_hi:[1,0,1]
    v_pk_fma_f32 v[82:83], v[62:63], v[140:141], v[82:83] op_sel_hi:[1,0,1]
    v_cvt_pk_bf16_f32 v114, v80, v81
    v_cvt_pk_bf16_f32 v115, v82, v83
    ds_write_b64 v4, v[114:115] offset:96
    s_waitcnt lgkmcnt(4)
    v_pk_fma_f32 v[84:85], v[64:65], v[140:141], v[84:85] op_sel_hi:[1,0,1]
    v_pk_fma_f32 v[86:87], v[66:67], v[140:141], v[86:87] op_sel_hi:[1,0,1]
    v_cvt_pk_bf16_f32 v116, v84, v85
    v_cvt_pk_bf16_f32 v117, v86, v87
    ds_write_b64 v4, v[116:117] offset:128
    s_waitcnt lgkmcnt(0)
    ds_read_b128 v[120:123], v5 offset:0
    ds_read_b128 v[124:127], v5 offset:1024
    ds_read_b128 v[128:131], v5 offset:2048
    s_waitcnt lgkmcnt(2)
    buffer_store_dwordx4 v[120:123], v152, s[48:51], s70 offen nt
    s_waitcnt lgkmcnt(1)
    buffer_store_dwordx4 v[124:127], v153, s[48:51], s70 offen nt
    s_waitcnt lgkmcnt(0)
    s_mov_b32 exec_hi, 0
    buffer_store_dwordx4 v[128:131], v154, s[48:51], s70 offen nt
F_end:
    s_endpgm
F_helper:
    v_add_u32 v8, s30, v7
    v_add_u32 v9, 61440, v8
    v_add_u32 v10, 122880, v8
    s_mul_i32 s62, s59, 122880
    s_sub_u32 s63, s3, s30
    s_barrier
    s_add_u32 s18, s3, 0x1614000
    buffer_load_dwordx4 v[56:59], v7, s[8:11], s18 offen
    s_add_u32 s18, s3, 0x1615000
    buffer_load_dwordx4 v[60:63], v7, s[8:11], s18 offen
    s_add_u32 s18, s3, 0x1616000
    buffer_load_dwordx4 v[64:67], v7, s[8:11], s18 offen
    s_add_u32 s18, s3, 0x1617000
    buffer_load_dwordx4 v[68:71], v7, s[8:11], s18 offen
    s_add_u32 s18, s3, 0x1618000
    buffer_load_dwordx4 v[72:75], v7, s[8:11], s18 offen
    s_add_u32 s18, s3, 0x1632000
    buffer_load_dwordx4 v[76:79], v7, s[8:11], s18 offen
    s_add_u32 s18, s3, 0x1633000
    buffer_load_dwordx4 v[80:83], v7, s[8:11], s18 offen
    s_add_u32 s18, s3, 0x1634000
    buffer_load_dwordx4 v[84:87], v7, s[8:11], s18 offen
    s_add_u32 s18, s3, 0x1635000
    buffer_load_dwordx4 v[88:91], v7, s[8:11], s18 offen
    s_add_u32 s18, s3, 0x1636000
    buffer_load_dwordx4 v[92:95], v7, s[8:11], s18 offen
    s_add_u32 s18, s3, 0x1631000
    buffer_load_dwordx4 v[136:139], v7, s[8:11], s18 offen
    s_barrier
    s_add_u32 s60, s30, 122880
    s_add_u32 s61, s63, 0x15e2000
F_b1:
    s_mov_b32 m0, s60
    s_add_u32 s18, s61, s60
    buffer_load_dwordx4 v7, s[8:11], s18 offen lds
    s_add_u32 s60, s60, 4096
    s_cmp_lt_u32 s60, 143360
    s_cbranch_scc1 F_b1
    s_add_u32 s60, s30, 143360
    s_add_u32 s61, s63, 0x15fb000
F_b2:
    s_mov_b32 m0, s60
    s_add_u32 s18, s61, s60
    buffer_load_dwordx4 v7, s[8:11], s18 offen lds
    s_add_u32 s60, s60, 4096
    s_cmp_lt_u32 s60, 163840
    s_cbranch_scc1 F_b2
    s_barrier
    s_add_u32 s60, s30, 98304
    s_add_u32 s61, s62, 0x1400000
F_b3:
    s_mov_b32 m0, s60
    s_add_u32 s18, s61, s60
    buffer_load_dwordx4 v7, s[8:11], s18 offen lds
    s_add_u32 s60, s60, 4096
    s_cmp_lt_u32 s60, 122880
    s_cbranch_scc1 F_b3
    s_barrier
    ds_write_b128 v8, v[160:163] offset:0
    ds_write_b128 v8, v[164:167] offset:4096
    ds_write_b128 v8, v[168:171] offset:8192
    ds_write_b128 v8, v[172:175] offset:12288
    ds_write_b128 v8, v[176:179] offset:16384
    ds_write_b128 v8, v[180:183] offset:20480
    ds_write_b128 v8, v[184:187] offset:24576
    ds_write_b128 v8, v[188:191] offset:28672
    ds_write_b128 v8, v[192:195] offset:32768
    s_barrier
    ds_write_b128 v8, v[196:199] offset:36864
    ds_write_b128 v8, v[200:203] offset:40960
    ds_write_b128 v8, v[204:207] offset:45056
    ds_write_b128 v8, v[140:143] offset:49152
    ds_write_b128 v8, v[144:147] offset:53248
    ds_write_b128 v8, v[148:151] offset:57344
    s_waitcnt vmcnt(0)
    s_barrier
    s_add_u32 s18, s3, 0x1619000
    buffer_load_dwordx4 v[96:99], v7, s[8:11], s18 offen
    s_add_u32 s18, s3, 0x161a000
    buffer_load_dwordx4 v[100:103], v7, s[8:11], s18 offen
    s_add_u32 s18, s3, 0x161b000
    buffer_load_dwordx4 v[104:107], v7, s[8:11], s18 offen
    s_add_u32 s18, s3, 0x161c000
    buffer_load_dwordx4 v[108:111], v7, s[8:11], s18 offen
    s_add_u32 s18, s3, 0x161d000
    buffer_load_dwordx4 v[112:115], v7, s[8:11], s18 offen
    s_add_u32 s18, s3, 0x1637000
    buffer_load_dwordx4 v[116:119], v7, s[8:11], s18 offen
    s_add_u32 s18, s3, 0x1638000
    buffer_load_dwordx4 v[120:123], v7, s[8:11], s18 offen
    s_add_u32 s18, s3, 0x1639000
    buffer_load_dwordx4 v[124:127], v7, s[8:11], s18 offen
    s_add_u32 s18, s3, 0x163a000
    buffer_load_dwordx4 v[128:131], v7, s[8:11], s18 offen
    s_add_u32 s18, s3, 0x163b000
    buffer_load_dwordx4 v[132:135], v7, s[8:11], s18 offen
    ds_write_b128 v9, v[208:211] offset:0
    ds_write_b128 v9, v[212:215] offset:4096
    ds_write_b128 v9, v[216:219] offset:8192
    ds_write_b128 v9, v[220:223] offset:12288
    ds_write_b128 v9, v[224:227] offset:16384
    ds_write_b128 v9, v[228:231] offset:20480
    ds_write_b128 v9, v[232:235] offset:24576
    s_waitcnt lgkmcnt(0)
    s_barrier
    ds_write_b128 v9, v[236:239] offset:28672
    ds_write_b128 v9, v[240:243] offset:32768
    ds_write_b128 v9, v[244:247] offset:36864
    ds_write_b128 v9, v[248:251] offset:40960
    ds_write_b128 v9, v[252:255] offset:45056
    ds_write_b128 v9, v[152:155] offset:49152
    ds_write_b128 v9, v[156:159] offset:53248
    ds_write_b128 v9, v[136:139] offset:57344
    s_waitcnt lgkmcnt(0)
    s_barrier
    ds_write_b128 v10, v[56:59] offset:0
    ds_write_b128 v10, v[60:63] offset:4096
    ds_write_b128 v10, v[64:67] offset:8192
    ds_write_b128 v10, v[68:71] offset:12288
    ds_write_b128 v10, v[72:75] offset:16384
    ds_write_b128 v10, v[76:79] offset:20480
    s_barrier
    ds_write_b128 v10, v[80:83] offset:24576
    ds_write_b128 v10, v[84:87] offset:28672
    ds_write_b128 v10, v[88:91] offset:32768
    ds_write_b128 v10, v[92:95] offset:36864
    s_waitcnt vmcnt(0)
    ds_write_b128 v8, v[96:99] offset:0
    ds_write_b128 v8, v[100:103] offset:4096
    ds_write_b128 v8, v[104:107] offset:8192
    ds_write_b128 v8, v[108:111] offset:12288
    s_waitcnt lgkmcnt(0)
    s_barrier
    ds_write_b128 v8, v[112:115] offset:16384
    ds_write_b128 v9, v[116:119] offset:0
    ds_write_b128 v9, v[120:123] offset:4096
    ds_write_b128 v9, v[124:127] offset:8192
    ds_write_b128 v9, v[128:131] offset:12288
    ds_write_b128 v9, v[132:135] offset:16384
    s_waitcnt lgkmcnt(0)
    s_barrier
    s_endpgm
F_st0:
    buffer_store_dwordx4 v[132:135], v13, s[8:11], s69 offen sc1
    s_branch F_sb0
F_st1:
    buffer_store_dwordx2 v[136:137], v12, s[8:11], s68 offen sc1
    s_branch F_sb1
F_st2:
    buffer_store_dword v3, v2, s[8:11], s17 offen sc1
    s_branch F_sb2
F_st3:
    buffer_store_dwordx4 v[108:111], v157, s[8:11], s62 offen offset:0 sc1
    s_branch F_sb3
F_st4:
    buffer_store_dwordx4 v[112:115], v157, s[8:11], s62 offen offset:2048 sc1
    s_branch F_sb4
F_st5:
    buffer_store_dwordx2 v[116:117], v156, s[8:11], s63 offen sc1
    s_branch F_sb5
F_st6:
    buffer_store_dword v28, v2, s[8:11], s60 offen sc1
    s_branch F_sb6
F_st7:
    buffer_store_dword v3, v2, s[8:11], s17 offen sc1
    s_branch F_sb7
F_st8:
    buffer_store_dword v46, v5, s[8:11], s17 offen sc1
    s_branch F_sb8
F_st9:
    buffer_store_dwordx4 v[208:211], v4, s[8:11], s19 offen offset:0 sc1
    s_branch F_sb9
F_st10:
    buffer_store_dwordx4 v[212:215], v4, s[8:11], s19 offen offset:512 sc1
    s_branch F_sb10
F_st11:
    buffer_store_dwordx4 v[216:219], v4, s[8:11], s19 offen offset:1024 sc1
    s_branch F_sb11
F_st12:
    buffer_store_dwordx4 v[220:223], v4, s[8:11], s19 offen offset:1536 sc1
    s_branch F_sb12
F_st13:
    buffer_store_dwordx4 v[224:227], v4, s[8:11], s19 offen offset:2048 sc1
    s_branch F_sb13
F_st14:
    buffer_store_dwordx4 v[228:231], v4, s[8:11], s19 offen offset:2560 sc1
    s_branch F_sb14
F_st15:
    buffer_store_dword v3, v2, s[8:11], s17 offen sc1
    s_branch F_sb15
F_full:
    s_mov_b32 s17, 19496960
    s_mov_b32 s19, 65536
    s_mov_b32 exec_hi, 0
F_full1:
    buffer_load_dwordx4 v[196:199], v192, s[8:11], s17 offen sc1
    s_waitcnt vmcnt(0)
    v_and_b32 v196, v196, v197
    v_and_b32 v198, v198, v199
    v_and_b32 v196, v196, v198
    v_cmp_ne_u32 vcc, 1, v196
    s_cbranch_vccz F_full2
    s_sub_u32 s19, s19, 1
    s_cbranch_scc0 F_full1
F_full2:
    s_mov_b32 exec_hi, -1
    s_branch F_fullx
F_wspin:
    s_mov_b32 s19, 65536
F_wsp1:
    s_sleep 4
    s_mov_b32 exec_lo, s16
    s_mov_b32 exec_hi, 0
    buffer_load_dwordx4 v[252:255], v4, s[8:11], s61 offen sc1
    s_mov_b64 exec, -1
    s_waitcnt vmcnt(0)
    v_and_b32 v252, v252, v253
    v_and_b32 v254, v254, v255
    v_and_b32 v252, v252, v254
    s_mov_b32 exec_lo, s16
    s_mov_b32 exec_hi, 0
    v_cmp_ne_u32 vcc, 1, v252
    s_mov_b64 exec, -1
    s_cbranch_vccz F_wok
    s_sub_u32 s19, s19, 1
    s_cbranch_scc0 F_wsp1
    s_branch F_wok
F_retry:
    s_waitcnt vmcnt(0) lgkmcnt(0)
    s_barrier
    s_mov_b32 s23, 1
    s_mov_b32 s24, 64
    v_and_b32 v2, 0x1f0, v7
    v_lshl_add_u32 v9, v6, 11, v2
    v_add_u32 v9, s32, v9
    v_add_u32 v3, 0x1000, v2
    v_mov_b32 v4, 5440
    v_cndmask_b32 v10, v4, v3, s[40:41]
    v_add_u32 v10, s32, v10
    s_add_u32 s17, s32, 5120
    v_add_u32 v11, s17, v7
    s_mov_b32 exec_lo, 0xffe00000
    s_mov_b32 exec_hi, 0xffe00000
    v_mov_b32 v11, 0x80000
    s_mov_b64 exec, -1
    v_lshl_add_u32 v12, v6, 15, v2
    v_add_u32 v13, 65536, v2
    s_cmp_eq_u32 s14, 0
    s_cbranch_scc1 F_r1
    v_subrev_u32 v3, 256, v0
    v_lshrrev_b32 v4, 4, v3
    v_mul_u32_u24 v4, 13312, v4
    v_and_b32 v3, 15, v0
    v_lshl_add_u32 v4, v3, 9, v4
    v_mov_b32 v132, 0x3f803f80
    v_mov_b32 v133, 0x3f803f80
    v_mov_b32 v134, 0x3f803f80
    v_mov_b32 v135, 0x3f803f80
    s_cmp_eq_u32 s12, 7
    s_cbranch_scc1 F_noonesb
    ds_write_b128 v4, v[132:135] offset:5440
F_noonesb:
F_r1:
    s_add_u32 m0, s29, 0
    s_add_u32 s18, s26, 3072
    buffer_load_dwordx4 v7, s[8:11], s18 offen sc1 lds
    s_add_u32 m0, s32, 4096
    s_add_u32 s18, s27, 68608
    s_mov_b64 exec, s[36:37]
    buffer_load_dwordx4 v7, s[8:11], s18 offen sc1 lds
    s_mov_b64 exec, -1
    s_add_u32 m0, s31, 5120
    s_add_u32 s18, s28, 5734400
    s_mov_b64 exec, s[34:35]
    buffer_load_dwordx4 v8, s[8:11], s18 offen sc1 lds
    s_add_u32 m0, m0, 1024
    s_add_u32 s18, s18, 20480
    buffer_load_dwordx4 v8, s[8:11], s18 offen sc1 lds
    s_mov_b64 exec, -1
    s_mov_b32 s25, s21
    s_add_u32 s18, s25, 16384
    buffer_load_dwordx2 v[36:37], v12, s[8:11], s25 offen
    buffer_load_dwordx2 v[38:39], v12, s[8:11], s18 offen
    buffer_load_dwordx2 v[48:49], v13, s[8:11], s25 offen
    s_waitcnt vmcnt(0)
    s_branch F_maxpass
code_end:
.section .rodata,"a"
.p2align 6
.amdhsa_kernel sequential_preLN__mha_block__dense_activation_squared_relu__prompt_kernel
  .amdhsa_next_free_vgpr 256
  .amdhsa_next_free_sgpr 72
  .amdhsa_accum_offset 256
  .amdhsa_group_segment_fixed_size 0
  .amdhsa_kernarg_size 88
  .amdhsa_user_sgpr_count 2
  .amdhsa_user_sgpr_kernarg_segment_ptr 1
  .amdhsa_system_sgpr_workgroup_id_x 1
.end_amdhsa_kernel
```
